```python
import torch

def _softmax(x, axis=-1):
    return torch.softmax(x, dim=axis)
def _gelu(x):
    return torch.nn.functional.gelu(x, approximate="tanh")
def _silu(x):
    return torch.nn.functional.silu(x)
def _sigmoid(x):
    return torch.sigmoid(x)
def _layernorm(x, axis=-1, eps=1e-5):
    m = x.mean(dim=axis, keepdim=True)
    v = x.var(dim=axis, keepdim=True, unbiased=False)
    return (x - m) / torch.sqrt(v + eps)
def _scatter_add(tgt, idx, src, axis=0):
    return tgt.clone().index_add_(axis, idx, src)
def _segment_sum(src, seg, n):
    out = torch.zeros((n,) + src.shape[1:], dtype=src.dtype)
    return out.index_add_(0, seg, src)
def _pad(x, pw):
    flat = tuple(v for pair in reversed(pw) for v in pair)
    return torch.nn.functional.pad(x, flat)

kernel_name = 'sequential_preLN__sliding_block_cached__dense_activation_gelu__decode'

def setup_inputs():

    _w = (lambda a: (lambda t: t.to(torch.bfloat16) if t.is_floating_point() else t)(torch.as_tensor(a)))
    def _A_setup():
        B, Sq, D = 8, 1, 512
        Hq, Hkv, Sk, Dh = 32, 32, 4096, 128
        assert Hq % Hkv == 0, (Hq, Hkv)
        return {
            "x": _w((lambda *s: torch.randn(*s, dtype=torch.bfloat16) * 0.05)(B, Sq, D)),
            "k_cache": _w((lambda *s: torch.randn(*s, dtype=torch.bfloat16) * 1.6)(B, Hkv, Sk, Dh)),
            "v_cache": _w((lambda *s: torch.randn(*s, dtype=torch.bfloat16) * 0.4)(B, Hkv, Sk, Dh)),
            "wq": _w((lambda *s: torch.randn(*s, dtype=torch.bfloat16) * 1.6)(D, Hq * Dh) * (D ** -0.5)),
            "wo": _w((lambda *s: torch.randn(*s, dtype=torch.bfloat16) * 0.4)(Hq * Dh, D) * ((Hq * Dh) ** -0.5)),
        }
    _A_in = _A_setup()

    def _B_setup():
        B, S, D, F = 8, 1, 512, 1376
        return {
            "x": _w((lambda *s: torch.randn(*s, dtype=torch.bfloat16) * 0.05)(B, S, D)),
            "w1": _w((lambda *s: torch.randn(*s, dtype=torch.bfloat16) * 0.8)(D, F) * (D ** -0.5)),
            "b1": _w((lambda *s: torch.randn(*s, dtype=torch.bfloat16) * 0.8)(F) * 0.01),
            "w2": _w((lambda *s: torch.randn(*s, dtype=torch.bfloat16) * 0.1)(F, D) * (F ** -0.5)),
            "b2": _w((lambda *s: torch.randn(*s, dtype=torch.bfloat16) * 0.1)(D) * 0.01),
        }
    _B_in = _B_setup()

    return {
        "A_x": _A_in["x"],
        "A_k_cache": _A_in["k_cache"],
        "A_v_cache": _A_in["v_cache"],
        "A_wq": _A_in["wq"],
        "A_wo": _A_in["wo"],
        "B_x": _B_in["x"],
        "B_w1": _B_in["w1"],
        "B_b1": _B_in["b1"],
        "B_w2": _B_in["w2"],
        "B_b2": _B_in["b2"],
    }

def reference(A_x, A_k_cache, A_v_cache, A_wq, A_wo, B_x, B_w1, B_b1, B_w2, B_b2):
    def _A_ref(x, k_cache, v_cache, wq, wo):
        B, Sq, D = x.shape
        Hq, Dh = 32, 128
        Hkv, Sk = k_cache.shape[1], k_cache.shape[2]
        W = min(4096, max(256, Sk // 4))
        rep = Hq // Hkv
        q = (lambda x, *d: x.permute(*d))((x @ wq).reshape(B, Sq, Hq, Dh), 0, 2, 1, 3)
        k = (lambda x, n, axis: torch.repeat_interleave(x, n, dim=axis))(k_cache[:, :, Sk - W:, :], rep, axis=1)
        v = (lambda x, n, axis: torch.repeat_interleave(x, n, dim=axis))(v_cache[:, :, Sk - W:, :], rep, axis=1)
        scores = torch.einsum("bhqd,bhkd->bhqk", q, k) * (Dh ** -0.5)
        p = _softmax(scores, axis=-1)
        o = torch.einsum("bhqk,bhkd->bhqd", p, v)
        return (lambda x, *d: x.permute(*d))(o, 0, 2, 1, 3).reshape(B, Sq, Hq * Dh) @ wo

    def _B_ref(x, w1, b1, w2, b2):
        h = torch.einsum("bsd,df->bsf", x, w1) + b1
        h = _gelu(h)
        return torch.einsum("bsf,fd->bsd", h, w2) + b2

    x = A_x
    h = x + _A_ref(_layernorm(x, axis=-1), A_k_cache, A_v_cache, A_wq, A_wo)
    h2 = h + _B_ref(_layernorm(h, axis=-1), B_w1, B_b1, B_w2, B_b2)
    return h2
```

```asm
; @launch grid=(256,1,1) block=(256,1,1) lds=13568
.amdgcn_target "amdgcn-amd-amdhsa--gfx950"
.text
.globl sequential_preLN__sliding_block_cached__dense_activation_gelu__decode_kernel
.p2align 12
.p2align 8
.type sequential_preLN__sliding_block_cached__dense_activation_gelu__decode_kernel,@function
sequential_preLN__sliding_block_cached__dense_activation_gelu__decode_kernel:
    s_load_dwordx8 s[4:11], s[0:1], 0
    s_load_dwordx8 s[12:19], s[0:1], 32
    s_load_dwordx8 s[20:27], s[0:1], 64
    s_load_dwordx2 s[28:29], s[0:1], 96
    s_cmp_ge_u32 s2, 256
    s_cbranch_scc1 L_end
    v_lshrrev_b32 v13, 6, v0
    v_and_b32 v10, 63, v0
    v_readfirstlane_b32 s3, v13
    v_lshrrev_b32 v11, 4, v10
    v_and_b32 v12, 15, v0
    s_lshr_b32 s30, s2, 5
    s_and_b32 s31, s2, 31
    v_lshlrev_b32 v2, 11, v13
    v_lshl_add_u32 v1, v11, 9, v2
    v_lshl_add_u32 v1, v12, 4, v1
    v_lshl_add_u32 v2, v10, 4, v2
    v_lshlrev_b32 v3, 13, v11
    v_lshl_add_u32 v3, v12, 4, v3
    s_lshl_b32 s66, s30, 10
    v_lshl_add_u32 v54, v10, 4, s66
    v_lshlrev_b32 v55, 8, v13
    v_lshl_add_u32 v8, v12, 4, v55
    v_lshl_add_u32 v28, v11, 2, v8
    v_add_u32 v26, s66, v28
    v_lshlrev_b32 v25, 4, v0
    v_cmp_gt_u32 vcc, 2176, v25
    v_mov_b32 v52, 0x1000000
    v_mov_b32 v40, -1
    v_mov_b32 v41, -1
    v_mov_b32 v42, -1
    v_mov_b32 v43, -1
    v_cndmask_b32 v25, v52, v25, vcc
    s_lshl_b32 s67, s2, 20
    s_add_u32 s67, s67, 0xC0000
    s_mul_i32 s70, s31, 2176
    s_mul_i32 s68, s30, 69632
    s_lshl_b32 s65, s3, 20
    s_lshl_b32 s69, s31, 8
    s_add_u32 s65, s65, s69
    s_mov_b32 s34, 0x40000
    s_mov_b32 s35, 0x20000
    s_mov_b32 s42, 0x400000
    s_mov_b32 s43, 0x20000
    s_mov_b32 s58, 0x11000
    s_mov_b32 s59, 0x20000
    s_mov_b32 s38, 0x40000
    s_mov_b32 s39, 0x20000
    s_mov_b32 s46, 0x400000
    s_mov_b32 s47, 0x20000
    s_mov_b32 s50, 0x158000
    s_mov_b32 s51, 0x20000
    s_mov_b32 s54, 0x158000
    s_mov_b32 s55, 0x20000
    s_mov_b32 s62, 0xac0
    s_mov_b32 s63, 0x20000
    s_waitcnt lgkmcnt(0)
    s_add_u32 s32, s6, s67
    s_addc_u32 s33, s7, 0
    s_mov_b32 s40, s10
    s_mov_b32 s41, s11
    s_add_u32 s56, s28, s68
    s_addc_u32 s57, s29, 0
    global_load_dwordx4 v[56:59], v54, s[4:5]
    global_load_dword v23, v26, s[4:5]
    s_mov_b32 s64, 0
    buffer_load_dwordx4 v[64:67], v1, s[32:35], s64 offen nt
    buffer_load_dwordx4 v[68:71], v1, s[32:35], s64 offen offset:256 nt
    buffer_store_dwordx4 v[40:43], v25, s[56:59], s70 offen sc1
    s_mov_b32 s64, 8192
    buffer_load_dwordx4 v[72:75], v1, s[32:35], s64 offen nt
    buffer_load_dwordx4 v[76:79], v1, s[32:35], s64 offen offset:256 nt
    s_add_u32 s64, s65, 0
    buffer_load_dwordx4 a[0:3], v3, s[40:43], s64 offen
    s_add_u32 s64, s65, 32768
    buffer_load_dwordx4 a[4:7], v3, s[40:43], s64 offen
    s_mov_b32 s64, 16384
    buffer_load_dwordx4 v[80:83], v1, s[32:35], s64 offen nt
    buffer_load_dwordx4 v[84:87], v1, s[32:35], s64 offen offset:256 nt
    s_add_u32 s64, s65, 65536
    buffer_load_dwordx4 a[8:11], v3, s[40:43], s64 offen
    s_add_u32 s64, s65, 98304
    buffer_load_dwordx4 a[12:15], v3, s[40:43], s64 offen
    s_mov_b32 s64, 24576
    buffer_load_dwordx4 v[88:91], v1, s[32:35], s64 offen nt
    buffer_load_dwordx4 v[92:95], v1, s[32:35], s64 offen offset:256 nt
    s_cmp_eq_u32 s3, 0
    s_cbranch_scc1 L_pad1
    s_cmp_eq_u32 s3, 1
    s_cbranch_scc1 L_pad2
    s_cmp_eq_u32 s3, 2
    s_cbranch_scc1 L_pad3
    s_cmp_eq_u32 s3, 3
    s_cbranch_scc1 L_pad4
L_touched:
    s_add_u32 s36, s8, s67
    s_addc_u32 s37, s9, 0
    s_mov_b32 s44, s12
    s_mov_b32 s45, s13
    s_mov_b32 s48, s16
    s_mov_b32 s49, s17
    s_mov_b32 s52, s20
    s_mov_b32 s53, s21
    s_mov_b32 s60, s18
    s_mov_b32 s61, s19
    s_mov_b32 s76, 0xaaaaaaaa
    s_mov_b32 s77, 0xaaaaaaaa
    s_mov_b32 s78, 0xcccccccc
    s_mov_b32 s79, 0xcccccccc
    s_lshl_b32 s75, s31, 17
    s_and_b32 s14, s31, 7
    s_lshl_b32 s14, s14, 2
    s_lshr_b32 s66, s31, 3
    s_add_u32 s14, s14, s66
    s_cmp_eq_u32 s3, 0
    s_cselect_b32 s15, s14, 0x1000000
    s_cmp_eq_u32 s3, 1
    s_cselect_b32 s101, s14, 0x1000000
    s_and_b32 s14, s14, 0x1c
    s_lshr_b32 s14, 0x45761023, s14
    s_and_b32 s14, s14, 7
    s_lshl_b32 s14, s14, 2
    s_add_u32 s14, s14, s66
    s_mul_i32 s14, s14, 6
    s_mov_b32 s100, 6
    s_sub_i32 s68, 172, s14
    s_min_i32 s100, s100, s68
    s_max_i32 s100, s100, 0
    s_add_u32 s68, s14, s100
    s_min_u32 s68, s68, 172
    s_lshl_b32 s54, s68, 13
    s_lshl_b32 s73, s14, 4
    s_lshl_b32 s74, s14, 13
    s_and_b32 s66, s31, 15
    s_mul_i32 s66, s66, 2176
    s_add_u32 s12, s56, s66
    s_addc_u32 s13, s57, 0
    v_lshrrev_b32 v52, 1, v11
    v_and_b32 v53, 1, v11
    v_and_b32 v29, 7, v0
    v_bfe_u32 v54, v0, 3, 1
    v_and_b32 v22, 3, v0
    v_mul_u32_u24 v22, 0x5555, v22
    v_mov_b32 v60, 0xffff
    v_mov_b32 v61, 0xffff0000
    v_lshrrev_b32 v55, 2, v12
    v_cmp_eq_u32 vcc, 0, v55
    s_nop 1
    v_cndmask_b32 v14, 0, v60, vcc
    v_cndmask_b32 v16, 0, v61, vcc
    v_cmp_eq_u32 vcc, 1, v55
    s_nop 1
    v_cndmask_b32 v15, 0, v60, vcc
    v_cndmask_b32 v17, 0, v61, vcc
    v_and_b32 v18, 1, v0
    v_mul_u32_u24 v18, 0x5555, v18
    v_add_u32 v18, 0x8888, v18
    v_lshl_add_u32 v4, v11, 11, v8
    v_mul_u32_u24 v6, 24, v53
    v_add_u32 v6, v6, v52
    v_lshl_add_u32 v6, v6, 10, v8
    v_lshlrev_b32 v5, 1, v52
    v_lshl_add_u32 v5, v53, 4, v5
    v_lshl_add_u32 v5, v54, 6, v5
    v_lshl_add_u32 v5, v13, 7, v5
    v_mul_u32_u24 v5, 2752, v5
    v_lshl_add_u32 v5, v29, 4, v5
    v_cmp_gt_i32 vcc, s100, v29
    v_mov_b32 v55, 0x7fff0000
    s_nop 0
    v_cndmask_b32 v5, v55, v5, vcc
    v_lshl_add_u32 v7, v11, 3, v8
    v_mul_u32_u24 v55, 17408, v11
    v_add_u32 v8, v8, v55
    v_lshlrev_b32 v9, 4, v10
    v_lshlrev_b32 v27, 1, v7
    v_mov_b32 v36, 0
    v_mov_b32 v37, 0
    v_mov_b32 v38, 0
    v_mov_b32 v39, 0
    s_add_u32 s64, s65, 131072
    buffer_load_dwordx4 a[16:19], v3, s[40:43], s64 offen
    s_add_u32 s64, s65, 163840
    buffer_load_dwordx4 a[20:23], v3, s[40:43], s64 offen
    s_mov_b32 s64, 32768
    buffer_load_dwordx4 v[96:99], v1, s[32:35], s64 offen nt
    buffer_load_dwordx4 v[100:103], v1, s[32:35], s64 offen offset:256 nt
    s_add_u32 s64, s65, 196608
    buffer_load_dwordx4 a[24:27], v3, s[40:43], s64 offen
    s_add_u32 s64, s65, 229376
    buffer_load_dwordx4 a[28:31], v3, s[40:43], s64 offen
    s_mov_b32 s64, 40960
    buffer_load_dwordx4 v[104:107], v1, s[32:35], s64 offen nt
    buffer_load_dwordx4 v[108:111], v1, s[32:35], s64 offen offset:256 nt
    s_add_u32 s64, s65, 262144
    buffer_load_dwordx4 a[32:35], v3, s[40:43], s64 offen
    s_add_u32 s64, s65, 294912
    buffer_load_dwordx4 a[36:39], v3, s[40:43], s64 offen
    s_mov_b32 s64, 49152
    buffer_load_dwordx4 v[112:115], v1, s[32:35], s64 offen nt
    buffer_load_dwordx4 v[116:119], v1, s[32:35], s64 offen offset:256 nt
    s_waitcnt vmcnt(25)
    v_lshlrev_b32 v48, 16, v56
    v_and_b32 v49, 0xffff0000, v56
    v_lshlrev_b32 v50, 16, v57
    v_and_b32 v51, 0xffff0000, v57
    v_lshlrev_b32 v60, 16, v58
    v_and_b32 v61, 0xffff0000, v58
    v_lshlrev_b32 v62, 16, v59
    v_and_b32 v63, 0xffff0000, v59
    v_lshlrev_b32 v34, 16, v23
    v_and_b32 v35, 0xffff0000, v23
    v_add_f32 v56, v48, v49
    v_add_f32 v57, v50, v51
    v_add_f32 v58, v60, v61
    v_add_f32 v59, v62, v63
    v_add_f32 v56, v56, v57
    v_add_f32 v58, v58, v59
    v_add_f32 v56, v56, v58
    s_nop 1
    v_add_f32_dpp v56, v56, v56 row_ror:8 row_mask:0xf bank_mask:0xf
    s_nop 1
    v_add_f32_dpp v56, v56, v56 row_ror:4 row_mask:0xf bank_mask:0xf
    s_nop 1
    v_add_f32_dpp v56, v56, v56 row_ror:2 row_mask:0xf bank_mask:0xf
    s_nop 1
    v_add_f32_dpp v56, v56, v56 row_ror:1 row_mask:0xf bank_mask:0xf
    s_nop 1
    v_add_f32_dpp v56, v56, v56 row_bcast:15 row_mask:0xa bank_mask:0xf
    s_nop 1
    v_add_f32_dpp v56, v56, v56 row_bcast:31 row_mask:0xc bank_mask:0xf
    s_nop 0
    v_readlane_b32 s66, v56, 63
    v_mov_b32 v57, 0x3b000000
    s_nop 0
    v_mul_f32 v57, s66, v57
    v_sub_f32 v48, v48, v57
    v_sub_f32 v49, v49, v57
    v_sub_f32 v50, v50, v57
    v_sub_f32 v51, v51, v57
    v_sub_f32 v60, v60, v57
    v_sub_f32 v61, v61, v57
    v_sub_f32 v62, v62, v57
    v_sub_f32 v63, v63, v57
    v_mul_f32 v56, v48, v48
    v_fmac_f32 v56, v49, v49
    v_fmac_f32 v56, v50, v50
    v_fmac_f32 v56, v51, v51
    v_fmac_f32 v56, v60, v60
    v_fmac_f32 v56, v61, v61
    v_fmac_f32 v56, v62, v62
    v_fmac_f32 v56, v63, v63
    s_nop 1
    v_add_f32_dpp v56, v56, v56 row_ror:8 row_mask:0xf bank_mask:0xf
    s_nop 1
    v_add_f32_dpp v56, v56, v56 row_ror:4 row_mask:0xf bank_mask:0xf
    s_mov_b32 s64, 57344
    buffer_load_dwordx4 v[120:123], v1, s[32:35], s64 offen nt
    buffer_load_dwordx4 v[124:127], v1, s[32:35], s64 offen offset:256 nt
    v_add_f32_dpp v56, v56, v56 row_ror:2 row_mask:0xf bank_mask:0xf
    s_nop 1
    v_add_f32_dpp v56, v56, v56 row_ror:1 row_mask:0xf bank_mask:0xf
    s_nop 1
    v_add_f32_dpp v56, v56, v56 row_bcast:15 row_mask:0xa bank_mask:0xf
    s_nop 1
    v_add_f32_dpp v56, v56, v56 row_bcast:31 row_mask:0xc bank_mask:0xf
    s_nop 0
    v_readlane_b32 s66, v56, 63
    v_mov_b32 v58, 0x3b000000
    s_nop 0
    v_mul_f32 v58, s66, v58
    v_cvt_pk_bf16_f32 v58, v57, v58
    v_lshlrev_b32 v57, 16, v58
    v_and_b32 v58, 0xffff0000, v58
    v_add_f32 v58, 0x3727c5ac, v58
    v_sub_f32 v60, v34, v57
    v_cvt_pk_bf16_f32 v58, v58, v58
    v_and_b32 v58, 0xffff0000, v58
    v_sqrt_f32 v58, v58
    v_sub_f32 v61, v35, v57
    v_cvt_pk_bf16_f32 v58, v58, v58
    v_and_b32 v58, 0xffff0000, v58
    v_rcp_f32 v58, v58
    v_cvt_pk_bf16_f32 v61, v60, v61
    v_lshlrev_b32 v60, 16, v61
    v_and_b32 v61, 0xffff0000, v61
    v_mul_f32 v60, v60, v58
    v_mul_f32 v61, v61, v58
    v_cvt_pk_bf16_f32 v23, v60, v61
    s_add_u32 s64, s65, 327680
    buffer_load_dwordx4 a[40:43], v3, s[40:43], s64 offen
    s_add_u32 s64, s65, 360448
    buffer_load_dwordx4 a[44:47], v3, s[40:43], s64 offen
    s_waitcnt vmcnt(10)
    v_and_b32_dpp v40, v23, v14 row_newbcast:0 row_mask:0xf bank_mask:0xf
    v_and_b32_dpp v41, v23, v15 row_newbcast:0 row_mask:0xf bank_mask:0xf
    v_and_b32_dpp v42, v23, v16 row_newbcast:0 row_mask:0xf bank_mask:0xf
    v_and_b32_dpp v43, v23, v17 row_newbcast:0 row_mask:0xf bank_mask:0xf
    s_nop 1
    v_smfmac_f32_16x16x64_bf16 v[36:39], v[40:43], a[0:7], v22
    v_and_b32_dpp v44, v23, v14 row_newbcast:1 row_mask:0xf bank_mask:0xf
    v_and_b32_dpp v45, v23, v15 row_newbcast:1 row_mask:0xf bank_mask:0xf
    v_and_b32_dpp v46, v23, v16 row_newbcast:1 row_mask:0xf bank_mask:0xf
    v_and_b32_dpp v47, v23, v17 row_newbcast:1 row_mask:0xf bank_mask:0xf
    s_nop 1
    v_smfmac_f32_16x16x64_bf16 v[36:39], v[44:47], a[8:15], v22
    v_and_b32_dpp v40, v23, v14 row_newbcast:2 row_mask:0xf bank_mask:0xf
    v_and_b32_dpp v41, v23, v15 row_newbcast:2 row_mask:0xf bank_mask:0xf
    v_and_b32_dpp v42, v23, v16 row_newbcast:2 row_mask:0xf bank_mask:0xf
    v_and_b32_dpp v43, v23, v17 row_newbcast:2 row_mask:0xf bank_mask:0xf
    s_nop 1
    v_smfmac_f32_16x16x64_bf16 v[36:39], v[40:43], a[16:23], v22
    v_and_b32_dpp v44, v23, v14 row_newbcast:3 row_mask:0xf bank_mask:0xf
    v_and_b32_dpp v45, v23, v15 row_newbcast:3 row_mask:0xf bank_mask:0xf
    v_and_b32_dpp v46, v23, v16 row_newbcast:3 row_mask:0xf bank_mask:0xf
    v_and_b32_dpp v47, v23, v17 row_newbcast:3 row_mask:0xf bank_mask:0xf
    s_nop 1
    v_smfmac_f32_16x16x64_bf16 v[36:39], v[44:47], a[24:31], v22
    s_mov_b32 s64, 65536
    buffer_load_dwordx4 v[128:131], v1, s[32:35], s64 offen nt
    buffer_load_dwordx4 v[132:135], v1, s[32:35], s64 offen offset:256 nt
    s_waitcnt vmcnt(10)
    s_add_u32 s64, s65, 393216
    buffer_load_dwordx4 a[48:51], v3, s[40:43], s64 offen
    s_add_u32 s64, s65, 425984
    buffer_load_dwordx4 a[52:55], v3, s[40:43], s64 offen
    s_waitcnt vmcnt(10)
    v_and_b32_dpp v40, v23, v14 row_newbcast:4 row_mask:0xf bank_mask:0xf
    v_and_b32_dpp v41, v23, v15 row_newbcast:4 row_mask:0xf bank_mask:0xf
    v_and_b32_dpp v42, v23, v16 row_newbcast:4 row_mask:0xf bank_mask:0xf
    v_and_b32_dpp v43, v23, v17 row_newbcast:4 row_mask:0xf bank_mask:0xf
    s_nop 1
    v_smfmac_f32_16x16x64_bf16 v[36:39], v[40:43], a[32:39], v22
    s_mov_b32 s64, 73728
    buffer_load_dwordx4 v[136:139], v1, s[32:35], s64 offen nt
    buffer_load_dwordx4 v[140:143], v1, s[32:35], s64 offen offset:256 nt
    s_waitcnt vmcnt(10)
    s_add_u32 s64, s65, 458752
    buffer_load_dwordx4 a[56:59], v3, s[40:43], s64 offen
    s_add_u32 s64, s65, 491520
    buffer_load_dwordx4 a[60:63], v3, s[40:43], s64 offen
    s_waitcnt vmcnt(10)
    s_mov_b32 s64, 81920
    buffer_load_dwordx4 v[144:147], v1, s[32:35], s64 offen nt
    buffer_load_dwordx4 v[148:151], v1, s[32:35], s64 offen offset:256 nt
    s_waitcnt vmcnt(10)
    v_and_b32_dpp v44, v23, v14 row_newbcast:5 row_mask:0xf bank_mask:0xf
    v_and_b32_dpp v45, v23, v15 row_newbcast:5 row_mask:0xf bank_mask:0xf
    v_and_b32_dpp v46, v23, v16 row_newbcast:5 row_mask:0xf bank_mask:0xf
    v_and_b32_dpp v47, v23, v17 row_newbcast:5 row_mask:0xf bank_mask:0xf
    s_nop 1
    v_smfmac_f32_16x16x64_bf16 v[36:39], v[44:47], a[40:47], v22
    s_add_u32 s64, s65, 524288
    buffer_load_dwordx4 a[64:67], v3, s[40:43], s64 offen
    s_add_u32 s64, s65, 557056
    buffer_load_dwordx4 a[68:71], v3, s[40:43], s64 offen
    s_waitcnt vmcnt(10)
    s_mov_b32 s64, 90112
    buffer_load_dwordx4 v[152:155], v1, s[32:35], s64 offen nt
    buffer_load_dwordx4 v[156:159], v1, s[32:35], s64 offen offset:256 nt
    s_waitcnt vmcnt(10)
    v_and_b32_dpp v40, v23, v14 row_newbcast:6 row_mask:0xf bank_mask:0xf
    v_and_b32_dpp v41, v23, v15 row_newbcast:6 row_mask:0xf bank_mask:0xf
    v_and_b32_dpp v42, v23, v16 row_newbcast:6 row_mask:0xf bank_mask:0xf
    v_and_b32_dpp v43, v23, v17 row_newbcast:6 row_mask:0xf bank_mask:0xf
    s_nop 1
    v_smfmac_f32_16x16x64_bf16 v[36:39], v[40:43], a[48:55], v22
    s_add_u32 s64, s65, 589824
    buffer_load_dwordx4 a[72:75], v3, s[40:43], s64 offen
    s_add_u32 s64, s65, 622592
    buffer_load_dwordx4 a[76:79], v3, s[40:43], s64 offen
    s_waitcnt vmcnt(10)
    s_mov_b32 s64, 98304
    buffer_load_dwordx4 v[160:163], v1, s[32:35], s64 offen nt
    buffer_load_dwordx4 v[164:167], v1, s[32:35], s64 offen offset:256 nt
    s_waitcnt vmcnt(10)
    v_and_b32_dpp v44, v23, v14 row_newbcast:7 row_mask:0xf bank_mask:0xf
    v_and_b32_dpp v45, v23, v15 row_newbcast:7 row_mask:0xf bank_mask:0xf
    v_and_b32_dpp v46, v23, v16 row_newbcast:7 row_mask:0xf bank_mask:0xf
    v_and_b32_dpp v47, v23, v17 row_newbcast:7 row_mask:0xf bank_mask:0xf
    s_nop 1
    v_smfmac_f32_16x16x64_bf16 v[36:39], v[44:47], a[56:63], v22
    s_mov_b32 s64, 106496
    buffer_load_dwordx4 v[168:171], v1, s[32:35], s64 offen nt
    buffer_load_dwordx4 v[172:175], v1, s[32:35], s64 offen offset:256 nt
    s_waitcnt vmcnt(10)
    s_add_u32 s64, s65, 655360
    buffer_load_dwordx4 a[80:83], v3, s[40:43], s64 offen
    s_add_u32 s64, s65, 688128
    buffer_load_dwordx4 a[84:87], v3, s[40:43], s64 offen
    s_waitcnt vmcnt(10)
    v_and_b32_dpp v40, v23, v14 row_newbcast:8 row_mask:0xf bank_mask:0xf
    v_and_b32_dpp v41, v23, v15 row_newbcast:8 row_mask:0xf bank_mask:0xf
    v_and_b32_dpp v42, v23, v16 row_newbcast:8 row_mask:0xf bank_mask:0xf
    v_and_b32_dpp v43, v23, v17 row_newbcast:8 row_mask:0xf bank_mask:0xf
    s_nop 1
    v_smfmac_f32_16x16x64_bf16 v[36:39], v[40:43], a[64:71], v22
    s_mov_b32 s64, 114688
    buffer_load_dwordx4 v[176:179], v1, s[32:35], s64 offen nt
    buffer_load_dwordx4 v[180:183], v1, s[32:35], s64 offen offset:256 nt
    s_waitcnt vmcnt(10)
    s_add_u32 s64, s65, 720896
    buffer_load_dwordx4 a[88:91], v3, s[40:43], s64 offen
    s_add_u32 s64, s65, 753664
    buffer_load_dwordx4 a[92:95], v3, s[40:43], s64 offen
    s_waitcnt vmcnt(10)
    v_and_b32_dpp v44, v23, v14 row_newbcast:9 row_mask:0xf bank_mask:0xf
    v_and_b32_dpp v45, v23, v15 row_newbcast:9 row_mask:0xf bank_mask:0xf
    v_and_b32_dpp v46, v23, v16 row_newbcast:9 row_mask:0xf bank_mask:0xf
    v_and_b32_dpp v47, v23, v17 row_newbcast:9 row_mask:0xf bank_mask:0xf
    s_nop 1
    v_smfmac_f32_16x16x64_bf16 v[36:39], v[44:47], a[72:79], v22
    s_mov_b32 s64, 122880
    buffer_load_dwordx4 v[184:187], v1, s[32:35], s64 offen nt
    buffer_load_dwordx4 v[188:191], v1, s[32:35], s64 offen offset:256 nt
    s_waitcnt vmcnt(10)
    s_add_u32 s64, s65, 786432
    buffer_load_dwordx4 a[96:99], v3, s[40:43], s64 offen
    s_add_u32 s64, s65, 819200
    buffer_load_dwordx4 a[100:103], v3, s[40:43], s64 offen
    s_waitcnt vmcnt(10)
    s_mov_b32 s64, 131072
    buffer_load_dwordx4 v[192:195], v1, s[32:35], s64 offen nt
    buffer_load_dwordx4 v[196:199], v1, s[32:35], s64 offen offset:256 nt
    s_waitcnt vmcnt(10)
    v_and_b32_dpp v40, v23, v14 row_newbcast:10 row_mask:0xf bank_mask:0xf
    v_and_b32_dpp v41, v23, v15 row_newbcast:10 row_mask:0xf bank_mask:0xf
    v_and_b32_dpp v42, v23, v16 row_newbcast:10 row_mask:0xf bank_mask:0xf
    v_and_b32_dpp v43, v23, v17 row_newbcast:10 row_mask:0xf bank_mask:0xf
    s_nop 1
    v_smfmac_f32_16x16x64_bf16 v[36:39], v[40:43], a[80:87], v22
    s_add_u32 s64, s65, 851968
    buffer_load_dwordx4 a[104:107], v3, s[40:43], s64 offen
    s_add_u32 s64, s65, 884736
    buffer_load_dwordx4 a[108:111], v3, s[40:43], s64 offen
    s_waitcnt vmcnt(10)
    s_mov_b32 s64, 139264
    buffer_load_dwordx4 v[200:203], v1, s[32:35], s64 offen nt
    buffer_load_dwordx4 v[204:207], v1, s[32:35], s64 offen offset:256 nt
    s_waitcnt vmcnt(10)
    v_and_b32_dpp v44, v23, v14 row_newbcast:11 row_mask:0xf bank_mask:0xf
    v_and_b32_dpp v45, v23, v15 row_newbcast:11 row_mask:0xf bank_mask:0xf
    v_and_b32_dpp v46, v23, v16 row_newbcast:11 row_mask:0xf bank_mask:0xf
    v_and_b32_dpp v47, v23, v17 row_newbcast:11 row_mask:0xf bank_mask:0xf
    s_nop 1
    v_smfmac_f32_16x16x64_bf16 v[36:39], v[44:47], a[88:95], v22
    s_add_u32 s64, s65, 917504
    buffer_load_dwordx4 a[112:115], v3, s[40:43], s64 offen
    s_add_u32 s64, s65, 950272
    buffer_load_dwordx4 a[116:119], v3, s[40:43], s64 offen
    s_waitcnt vmcnt(10)
    s_mov_b32 s64, 147456
    buffer_load_dwordx4 v[208:211], v1, s[32:35], s64 offen nt
    buffer_load_dwordx4 v[212:215], v1, s[32:35], s64 offen offset:256 nt
    s_waitcnt vmcnt(10)
    v_and_b32_dpp v40, v23, v14 row_newbcast:12 row_mask:0xf bank_mask:0xf
    v_and_b32_dpp v41, v23, v15 row_newbcast:12 row_mask:0xf bank_mask:0xf
    v_and_b32_dpp v42, v23, v16 row_newbcast:12 row_mask:0xf bank_mask:0xf
    v_and_b32_dpp v43, v23, v17 row_newbcast:12 row_mask:0xf bank_mask:0xf
    s_nop 1
    v_smfmac_f32_16x16x64_bf16 v[36:39], v[40:43], a[96:103], v22
    s_add_u32 s64, s65, 983040
    buffer_load_dwordx4 a[120:123], v3, s[40:43], s64 offen
    s_add_u32 s64, s65, 1015808
    buffer_load_dwordx4 a[124:127], v3, s[40:43], s64 offen
    s_branch L_pg1
.p2align 12
L_pad1:
    s_branch L_touched
    s_nop 0
L_pg1:
    s_waitcnt vmcnt(10)
    s_mov_b32 s64, 155648
    buffer_load_dwordx4 v[216:219], v1, s[32:35], s64 offen nt
    buffer_load_dwordx4 v[220:223], v1, s[32:35], s64 offen offset:256 nt
    s_waitcnt vmcnt(10)
    v_and_b32_dpp v44, v23, v14 row_newbcast:13 row_mask:0xf bank_mask:0xf
    v_and_b32_dpp v45, v23, v15 row_newbcast:13 row_mask:0xf bank_mask:0xf
    v_and_b32_dpp v46, v23, v16 row_newbcast:13 row_mask:0xf bank_mask:0xf
    v_and_b32_dpp v47, v23, v17 row_newbcast:13 row_mask:0xf bank_mask:0xf
    s_nop 1
    v_smfmac_f32_16x16x64_bf16 v[36:39], v[44:47], a[104:111], v22
    s_mov_b32 s64, 163840
    buffer_load_dwordx4 v[224:227], v1, s[32:35], s64 offen nt
    buffer_load_dwordx4 v[228:231], v1, s[32:35], s64 offen offset:256 nt
    s_waitcnt vmcnt(10)
    s_add_u32 s64, s73, 0
    buffer_load_dwordx4 a[128:131], v5, s[48:51], s64 offen
    s_add_u32 s64, s73, 2752
    buffer_load_dwordx4 a[132:135], v5, s[48:51], s64 offen
    s_waitcnt vmcnt(10)
    v_and_b32_dpp v40, v23, v14 row_newbcast:14 row_mask:0xf bank_mask:0xf
    v_and_b32_dpp v41, v23, v15 row_newbcast:14 row_mask:0xf bank_mask:0xf
    v_and_b32_dpp v42, v23, v16 row_newbcast:14 row_mask:0xf bank_mask:0xf
    v_and_b32_dpp v43, v23, v17 row_newbcast:14 row_mask:0xf bank_mask:0xf
    s_nop 1
    v_smfmac_f32_16x16x64_bf16 v[36:39], v[40:43], a[112:119], v22
    s_mov_b32 s64, 172032
    buffer_load_dwordx4 v[232:235], v1, s[32:35], s64 offen nt
    buffer_load_dwordx4 v[236:239], v1, s[32:35], s64 offen offset:256 nt
    s_waitcnt vmcnt(10)
    s_mov_b32 s64, 180224
    buffer_load_dwordx4 v[240:243], v1, s[32:35], s64 offen nt
    buffer_load_dwordx4 v[244:247], v1, s[32:35], s64 offen offset:256 nt
    s_waitcnt vmcnt(10)
    v_and_b32_dpp v44, v23, v14 row_newbcast:15 row_mask:0xf bank_mask:0xf
    v_and_b32_dpp v45, v23, v15 row_newbcast:15 row_mask:0xf bank_mask:0xf
    v_and_b32_dpp v46, v23, v16 row_newbcast:15 row_mask:0xf bank_mask:0xf
    v_and_b32_dpp v47, v23, v17 row_newbcast:15 row_mask:0xf bank_mask:0xf
    s_nop 1
    v_smfmac_f32_16x16x64_bf16 v[36:39], v[44:47], a[120:127], v22
    s_add_u32 s64, s73, 22016
    buffer_load_dwordx4 a[136:139], v5, s[48:51], s64 offen
    s_add_u32 s64, s73, 24768
    buffer_load_dwordx4 a[140:143], v5, s[48:51], s64 offen
    s_mov_b32 exec_hi, 0
    s_nop 2
    ds_write_b128 v27, v[36:39] offset:0
    s_mov_b32 exec_hi, -1
    v_lshlrev_b32 v26, 5, v12
    s_waitcnt lgkmcnt(0)
    s_barrier
    s_cmp_lg_u32 s3, 0
    s_cbranch_scc1 L_nosig
    s_lshl_b32 s66, s30, 5
    v_mov_b32 v52, s66
    v_mov_b32 v53, 1
    s_mov_b64 exec, 1
    global_atomic_add v52, v53, s[26:27] sc1
    s_mov_b64 exec, -1
L_nosig:
    s_mov_b32 s64, 188416
    buffer_load_dwordx4 v[248:251], v1, s[32:35], s64 offen nt
    buffer_load_dwordx4 v[252:255], v1, s[32:35], s64 offen offset:256 nt
    ds_read_b128 v[40:43], v26 offset:0
    ds_read_b128 v[44:47], v26 offset:512
    ds_read_b128 v[48:51], v26 offset:1024
    ds_read_b128 v[56:59], v26 offset:1536
    s_waitcnt lgkmcnt(0)
    v_add_f32 v40, v40, v44
    v_add_f32 v48, v48, v56
    v_add_f32 v41, v41, v45
    v_add_f32 v49, v49, v57
    v_add_f32 v42, v42, v46
    v_add_f32 v50, v50, v58
    v_add_f32 v43, v43, v47
    v_add_f32 v51, v51, v59
    v_add_f32 v40, v40, v48
    v_add_f32 v41, v41, v49
    v_add_f32 v42, v42, v50
    v_add_f32 v43, v43, v51
    v_cvt_pk_bf16_f32 v30, v40, v41
    v_cvt_pk_bf16_f32 v31, v42, v43
    ds_read_b128 v[40:43], v26 offset:16
    ds_read_b128 v[44:47], v26 offset:528
    ds_read_b128 v[48:51], v26 offset:1040
    ds_read_b128 v[56:59], v26 offset:1552
    s_waitcnt lgkmcnt(0)
    v_add_f32 v40, v40, v44
    v_add_f32 v48, v48, v56
    v_add_f32 v41, v41, v45
    v_add_f32 v49, v49, v57
    v_add_f32 v42, v42, v46
    v_add_f32 v50, v50, v58
    v_add_f32 v43, v43, v47
    v_add_f32 v51, v51, v59
    v_add_f32 v40, v40, v48
    v_add_f32 v41, v41, v49
    v_add_f32 v42, v42, v50
    v_add_f32 v43, v43, v51
    v_cvt_pk_bf16_f32 v32, v40, v41
    v_cvt_pk_bf16_f32 v33, v42, v43
    v_mov_b32 v36, 0
    v_mov_b32 v37, 0
    v_mov_b32 v38, 0
    v_mov_b32 v39, 0
    v_dot2_f32_bf16 v52, v64, v30, 0
    v_dot2_f32_bf16 v56, v68, v30, 0
    v_dot2_f32_bf16 v52, v65, v31, v52
    v_dot2_f32_bf16 v56, v69, v31, v56
    v_dot2_f32_bf16 v52, v66, v32, v52
    v_dot2_f32_bf16 v56, v70, v32, v56
    v_dot2_f32_bf16 v52, v67, v33, v52
    v_dot2_f32_bf16 v56, v71, v33, v56
    v_dot2_f32_bf16 v60, v72, v30, 0
    v_dot2_f32_bf16 v62, v76, v30, 0
    v_dot2_f32_bf16 v60, v73, v31, v60
    v_dot2_f32_bf16 v62, v77, v31, v62
    v_dot2_f32_bf16 v60, v74, v32, v60
    v_dot2_f32_bf16 v62, v78, v32, v62
    v_dot2_f32_bf16 v60, v75, v33, v60
    v_dot2_f32_bf16 v62, v79, v33, v62
    v_add_f32_dpp v52, v52, v52 row_ror:8 row_mask:0xf bank_mask:0x3
    v_add_f32_dpp v56, v56, v56 row_ror:8 row_mask:0xf bank_mask:0x3
    s_nop 0
    v_add_f32_dpp v52, v60, v60 row_ror:8 row_mask:0xf bank_mask:0xc
    v_add_f32_dpp v56, v62, v62 row_ror:8 row_mask:0xf bank_mask:0xc
    v_dot2_f32_bf16 v61, v80, v30, 0
    v_dot2_f32_bf16 v63, v84, v30, 0
    v_dot2_f32_bf16 v61, v81, v31, v61
    v_dot2_f32_bf16 v63, v85, v31, v63
    v_dot2_f32_bf16 v61, v82, v32, v61
    v_dot2_f32_bf16 v63, v86, v32, v63
    v_dot2_f32_bf16 v61, v83, v33, v61
    v_dot2_f32_bf16 v63, v87, v33, v63
    s_mov_b32 s64, 196608
    buffer_load_dwordx4 v[64:67], v1, s[32:35], s64 offen nt
    buffer_load_dwordx4 v[68:71], v1, s[32:35], s64 offen offset:256 nt
    s_waitcnt vmcnt(10)
    v_dot2_f32_bf16 v60, v88, v30, 0
    v_dot2_f32_bf16 v62, v92, v30, 0
    v_dot2_f32_bf16 v60, v89, v31, v60
    v_dot2_f32_bf16 v62, v93, v31, v62
    v_dot2_f32_bf16 v60, v90, v32, v60
    v_dot2_f32_bf16 v62, v94, v32, v62
    v_dot2_f32_bf16 v60, v91, v33, v60
    v_dot2_f32_bf16 v62, v95, v33, v62
    v_add_f32_dpp v61, v61, v61 row_ror:8 row_mask:0xf bank_mask:0x3
    v_add_f32_dpp v63, v63, v63 row_ror:8 row_mask:0xf bank_mask:0x3
    s_nop 0
    v_add_f32_dpp v61, v60, v60 row_ror:8 row_mask:0xf bank_mask:0xc
    v_add_f32_dpp v63, v62, v62 row_ror:8 row_mask:0xf bank_mask:0xc
    v_add_f32_dpp v52, v52, v52 row_half_mirror row_mask:0xf bank_mask:0x5
    v_add_f32_dpp v56, v56, v56 row_half_mirror row_mask:0xf bank_mask:0x5
    s_nop 0
    v_add_f32_dpp v52, v61, v61 row_half_mirror row_mask:0xf bank_mask:0xa
    v_add_f32_dpp v56, v63, v63 row_half_mirror row_mask:0xf bank_mask:0xa
    v_dot2_f32_bf16 v53, v96, v30, 0
    v_dot2_f32_bf16 v57, v100, v30, 0
    v_dot2_f32_bf16 v53, v97, v31, v53
    v_dot2_f32_bf16 v57, v101, v31, v57
    v_dot2_f32_bf16 v53, v98, v32, v53
    v_dot2_f32_bf16 v57, v102, v32, v57
    v_dot2_f32_bf16 v53, v99, v33, v53
    v_dot2_f32_bf16 v57, v103, v33, v57
    v_dot2_f32_bf16 v60, v104, v30, 0
    v_dot2_f32_bf16 v62, v108, v30, 0
    v_dot2_f32_bf16 v60, v105, v31, v60
    v_dot2_f32_bf16 v62, v109, v31, v62
    v_dot2_f32_bf16 v60, v106, v32, v60
    v_dot2_f32_bf16 v62, v110, v32, v62
    v_dot2_f32_bf16 v60, v107, v33, v60
    v_dot2_f32_bf16 v62, v111, v33, v62
    v_add_f32_dpp v53, v53, v53 row_ror:8 row_mask:0xf bank_mask:0x3
    v_add_f32_dpp v57, v57, v57 row_ror:8 row_mask:0xf bank_mask:0x3
    s_nop 0
    v_add_f32_dpp v53, v60, v60 row_ror:8 row_mask:0xf bank_mask:0xc
    v_add_f32_dpp v57, v62, v62 row_ror:8 row_mask:0xf bank_mask:0xc
    s_add_u32 s64, s73, 11008
    buffer_load_dwordx4 a[144:147], v5, s[48:51], s64 offen
    s_add_u32 s64, s73, 13760
    buffer_load_dwordx4 a[148:151], v5, s[48:51], s64 offen
    s_mov_b32 s64, 204800
    buffer_load_dwordx4 v[72:75], v1, s[32:35], s64 offen nt
    buffer_load_dwordx4 v[76:79], v1, s[32:35], s64 offen offset:256 nt
    s_waitcnt vmcnt(10)
    v_dot2_f32_bf16 v61, v112, v30, 0
    v_dot2_f32_bf16 v63, v116, v30, 0
    v_dot2_f32_bf16 v61, v113, v31, v61
    v_dot2_f32_bf16 v63, v117, v31, v63
    v_dot2_f32_bf16 v61, v114, v32, v61
    v_dot2_f32_bf16 v63, v118, v32, v63
    v_dot2_f32_bf16 v61, v115, v33, v61
    v_dot2_f32_bf16 v63, v119, v33, v63
    v_dot2_f32_bf16 v60, v120, v30, 0
    v_dot2_f32_bf16 v62, v124, v30, 0
    v_dot2_f32_bf16 v60, v121, v31, v60
    v_dot2_f32_bf16 v62, v125, v31, v62
    v_dot2_f32_bf16 v60, v122, v32, v60
    v_dot2_f32_bf16 v62, v126, v32, v62
    v_dot2_f32_bf16 v60, v123, v33, v60
    v_dot2_f32_bf16 v62, v127, v33, v62
    v_add_f32_dpp v61, v61, v61 row_ror:8 row_mask:0xf bank_mask:0x3
    v_add_f32_dpp v63, v63, v63 row_ror:8 row_mask:0xf bank_mask:0x3
    s_nop 0
    v_add_f32_dpp v61, v60, v60 row_ror:8 row_mask:0xf bank_mask:0xc
    v_add_f32_dpp v63, v62, v62 row_ror:8 row_mask:0xf bank_mask:0xc
    v_add_f32_dpp v53, v53, v53 row_half_mirror row_mask:0xf bank_mask:0x5
    v_add_f32_dpp v57, v57, v57 row_half_mirror row_mask:0xf bank_mask:0x5
    s_nop 0
    v_add_f32_dpp v53, v61, v61 row_half_mirror row_mask:0xf bank_mask:0xa
    v_add_f32_dpp v57, v63, v63 row_half_mirror row_mask:0xf bank_mask:0xa
    v_dot2_f32_bf16 v54, v128, v30, 0
    v_dot2_f32_bf16 v58, v132, v30, 0
    v_dot2_f32_bf16 v54, v129, v31, v54
    v_dot2_f32_bf16 v58, v133, v31, v58
    v_dot2_f32_bf16 v54, v130, v32, v54
    v_dot2_f32_bf16 v58, v134, v32, v58
    v_dot2_f32_bf16 v54, v131, v33, v54
    v_dot2_f32_bf16 v58, v135, v33, v58
    s_mov_b32 s64, 212992
    buffer_load_dwordx4 v[80:83], v1, s[32:35], s64 offen nt
    buffer_load_dwordx4 v[84:87], v1, s[32:35], s64 offen offset:256 nt
    s_waitcnt vmcnt(10)
    v_dot2_f32_bf16 v60, v136, v30, 0
    v_dot2_f32_bf16 v62, v140, v30, 0
    v_dot2_f32_bf16 v60, v137, v31, v60
    v_dot2_f32_bf16 v62, v141, v31, v62
    v_dot2_f32_bf16 v60, v138, v32, v60
    v_dot2_f32_bf16 v62, v142, v32, v62
    v_dot2_f32_bf16 v60, v139, v33, v60
    v_dot2_f32_bf16 v62, v143, v33, v62
    v_add_f32_dpp v54, v54, v54 row_ror:8 row_mask:0xf bank_mask:0x3
    v_add_f32_dpp v58, v58, v58 row_ror:8 row_mask:0xf bank_mask:0x3
    s_nop 0
    v_add_f32_dpp v54, v60, v60 row_ror:8 row_mask:0xf bank_mask:0xc
    v_add_f32_dpp v58, v62, v62 row_ror:8 row_mask:0xf bank_mask:0xc
    v_dot2_f32_bf16 v61, v144, v30, 0
    v_dot2_f32_bf16 v63, v148, v30, 0
    v_dot2_f32_bf16 v61, v145, v31, v61
    v_dot2_f32_bf16 v63, v149, v31, v63
    v_dot2_f32_bf16 v61, v146, v32, v61
    v_dot2_f32_bf16 v63, v150, v32, v63
    v_dot2_f32_bf16 v61, v147, v33, v61
    v_dot2_f32_bf16 v63, v151, v33, v63
    v_dot2_f32_bf16 v60, v152, v30, 0
    v_dot2_f32_bf16 v62, v156, v30, 0
    v_dot2_f32_bf16 v60, v153, v31, v60
    v_dot2_f32_bf16 v62, v157, v31, v62
    v_dot2_f32_bf16 v60, v154, v32, v60
    v_dot2_f32_bf16 v62, v158, v32, v62
    v_dot2_f32_bf16 v60, v155, v33, v60
    v_dot2_f32_bf16 v62, v159, v33, v62
    v_add_f32_dpp v61, v61, v61 row_ror:8 row_mask:0xf bank_mask:0x3
    v_add_f32_dpp v63, v63, v63 row_ror:8 row_mask:0xf bank_mask:0x3
    s_nop 0
    v_add_f32_dpp v61, v60, v60 row_ror:8 row_mask:0xf bank_mask:0xc
    v_add_f32_dpp v63, v62, v62 row_ror:8 row_mask:0xf bank_mask:0xc
    v_add_f32_dpp v54, v54, v54 row_half_mirror row_mask:0xf bank_mask:0x5
    v_add_f32_dpp v58, v58, v58 row_half_mirror row_mask:0xf bank_mask:0x5
    s_nop 0
    v_add_f32_dpp v54, v61, v61 row_half_mirror row_mask:0xf bank_mask:0xa
    v_add_f32_dpp v58, v63, v63 row_half_mirror row_mask:0xf bank_mask:0xa
    s_add_u32 s64, s73, 33024
    buffer_load_dwordx4 a[152:155], v5, s[48:51], s64 offen
    s_add_u32 s64, s73, 35776
    buffer_load_dwordx4 a[156:159], v5, s[48:51], s64 offen
    s_mov_b32 s64, 221184
    buffer_load_dwordx4 v[88:91], v1, s[32:35], s64 offen nt
    buffer_load_dwordx4 v[92:95], v1, s[32:35], s64 offen offset:256 nt
    s_waitcnt vmcnt(10)
    v_dot2_f32_bf16 v55, v160, v30, 0
    v_dot2_f32_bf16 v59, v164, v30, 0
    v_dot2_f32_bf16 v55, v161, v31, v55
    v_dot2_f32_bf16 v59, v165, v31, v59
    v_dot2_f32_bf16 v55, v162, v32, v55
    v_dot2_f32_bf16 v59, v166, v32, v59
    v_dot2_f32_bf16 v55, v163, v33, v55
    v_dot2_f32_bf16 v59, v167, v33, v59
    v_dot2_f32_bf16 v60, v168, v30, 0
    v_dot2_f32_bf16 v62, v172, v30, 0
    v_dot2_f32_bf16 v60, v169, v31, v60
    v_dot2_f32_bf16 v62, v173, v31, v62
    v_dot2_f32_bf16 v60, v170, v32, v60
    v_dot2_f32_bf16 v62, v174, v32, v62
    v_dot2_f32_bf16 v60, v171, v33, v60
    v_dot2_f32_bf16 v62, v175, v33, v62
    v_add_f32_dpp v55, v55, v55 row_ror:8 row_mask:0xf bank_mask:0x3
    v_add_f32_dpp v59, v59, v59 row_ror:8 row_mask:0xf bank_mask:0x3
    s_nop 0
    v_add_f32_dpp v55, v60, v60 row_ror:8 row_mask:0xf bank_mask:0xc
    v_add_f32_dpp v59, v62, v62 row_ror:8 row_mask:0xf bank_mask:0xc
    v_dot2_f32_bf16 v61, v176, v30, 0
    v_dot2_f32_bf16 v63, v180, v30, 0
    v_dot2_f32_bf16 v61, v177, v31, v61
    v_dot2_f32_bf16 v63, v181, v31, v63
    v_dot2_f32_bf16 v61, v178, v32, v61
    v_dot2_f32_bf16 v63, v182, v32, v63
    v_dot2_f32_bf16 v61, v179, v33, v61
    v_dot2_f32_bf16 v63, v183, v33, v63
    s_add_u32 s64, s73, 88064
    buffer_load_dwordx4 a[160:163], v5, s[48:51], s64 offen
    s_add_u32 s64, s73, 90816
    buffer_load_dwordx4 a[164:167], v5, s[48:51], s64 offen
    s_waitcnt vmcnt(10)
    v_dot2_f32_bf16 v60, v184, v30, 0
    v_dot2_f32_bf16 v62, v188, v30, 0
    v_dot2_f32_bf16 v60, v185, v31, v60
    v_dot2_f32_bf16 v62, v189, v31, v62
    v_dot2_f32_bf16 v60, v186, v32, v60
    v_dot2_f32_bf16 v62, v190, v32, v62
    v_dot2_f32_bf16 v60, v187, v33, v60
    v_dot2_f32_bf16 v62, v191, v33, v62
    v_add_f32_dpp v61, v61, v61 row_ror:8 row_mask:0xf bank_mask:0x3
    v_add_f32_dpp v63, v63, v63 row_ror:8 row_mask:0xf bank_mask:0x3
    s_nop 0
    v_add_f32_dpp v61, v60, v60 row_ror:8 row_mask:0xf bank_mask:0xc
    v_add_f32_dpp v63, v62, v62 row_ror:8 row_mask:0xf bank_mask:0xc
    v_add_f32_dpp v55, v55, v55 row_half_mirror row_mask:0xf bank_mask:0x5
    v_add_f32_dpp v59, v59, v59 row_half_mirror row_mask:0xf bank_mask:0x5
    s_nop 0
    v_add_f32_dpp v55, v61, v61 row_half_mirror row_mask:0xf bank_mask:0xa
    v_add_f32_dpp v59, v63, v63 row_half_mirror row_mask:0xf bank_mask:0xa
    v_add_f32_dpp v52, v52, v52 quad_perm:[1,0,3,2] row_mask:0xf bank_mask:0xf
    v_add_f32_dpp v53, v53, v53 quad_perm:[1,0,3,2] row_mask:0xf bank_mask:0xf
    v_add_f32_dpp v54, v54, v54 quad_perm:[1,0,3,2] row_mask:0xf bank_mask:0xf
    v_add_f32_dpp v55, v55, v55 quad_perm:[1,0,3,2] row_mask:0xf bank_mask:0xf
    v_add_f32_dpp v56, v56, v56 quad_perm:[1,0,3,2] row_mask:0xf bank_mask:0xf
    v_add_f32_dpp v57, v57, v57 quad_perm:[1,0,3,2] row_mask:0xf bank_mask:0xf
    v_add_f32_dpp v58, v58, v58 quad_perm:[1,0,3,2] row_mask:0xf bank_mask:0xf
    v_add_f32_dpp v59, v59, v59 quad_perm:[1,0,3,2] row_mask:0xf bank_mask:0xf
    v_cndmask_b32 v52, v52, v53, s[76:77]
    v_cndmask_b32 v54, v54, v55, s[76:77]
    v_cndmask_b32 v56, v56, v57, s[76:77]
    v_cndmask_b32 v58, v58, v59, s[76:77]
    s_mov_b32 s64, 229376
    buffer_load_dwordx4 v[96:99], v1, s[32:35], s64 offen nt
    buffer_load_dwordx4 v[100:103], v1, s[32:35], s64 offen offset:256 nt
    v_add_f32_dpp v52, v52, v52 quad_perm:[2,3,0,1] row_mask:0xf bank_mask:0xf
    v_add_f32_dpp v54, v54, v54 quad_perm:[2,3,0,1] row_mask:0xf bank_mask:0xf
    v_add_f32_dpp v56, v56, v56 quad_perm:[2,3,0,1] row_mask:0xf bank_mask:0xf
    v_add_f32_dpp v58, v58, v58 quad_perm:[2,3,0,1] row_mask:0xf bank_mask:0xf
    v_cndmask_b32 v48, v52, v54, s[78:79]
    v_cndmask_b32 v49, v56, v58, s[78:79]
    v_dot2_f32_bf16 v52, v192, v30, 0
    v_dot2_f32_bf16 v56, v196, v30, 0
    v_dot2_f32_bf16 v52, v193, v31, v52
    v_dot2_f32_bf16 v56, v197, v31, v56
    v_dot2_f32_bf16 v52, v194, v32, v52
    v_dot2_f32_bf16 v56, v198, v32, v56
    v_dot2_f32_bf16 v52, v195, v33, v52
    v_dot2_f32_bf16 v56, v199, v33, v56
    v_dot2_f32_bf16 v60, v200, v30, 0
    v_dot2_f32_bf16 v62, v204, v30, 0
    v_dot2_f32_bf16 v60, v201, v31, v60
    v_dot2_f32_bf16 v62, v205, v31, v62
    v_dot2_f32_bf16 v60, v202, v32, v60
    v_dot2_f32_bf16 v62, v206, v32, v62
    v_dot2_f32_bf16 v60, v203, v33, v60
    v_dot2_f32_bf16 v62, v207, v33, v62
    v_add_f32_dpp v52, v52, v52 row_ror:8 row_mask:0xf bank_mask:0x3
    v_add_f32_dpp v56, v56, v56 row_ror:8 row_mask:0xf bank_mask:0x3
    s_nop 0
    v_add_f32_dpp v52, v60, v60 row_ror:8 row_mask:0xf bank_mask:0xc
    v_add_f32_dpp v56, v62, v62 row_ror:8 row_mask:0xf bank_mask:0xc
    s_mov_b32 s64, 237568
    buffer_load_dwordx4 v[104:107], v1, s[32:35], s64 offen nt
    buffer_load_dwordx4 v[108:111], v1, s[32:35], s64 offen offset:256 nt
    s_waitcnt vmcnt(10)
    v_dot2_f32_bf16 v61, v208, v30, 0
    v_dot2_f32_bf16 v63, v212, v30, 0
    v_dot2_f32_bf16 v61, v209, v31, v61
    v_dot2_f32_bf16 v63, v213, v31, v63
    v_dot2_f32_bf16 v61, v210, v32, v61
    v_dot2_f32_bf16 v63, v214, v32, v63
    v_dot2_f32_bf16 v61, v211, v33, v61
    v_dot2_f32_bf16 v63, v215, v33, v63
    v_dot2_f32_bf16 v60, v216, v30, 0
    v_dot2_f32_bf16 v62, v220, v30, 0
    v_dot2_f32_bf16 v60, v217, v31, v60
    v_dot2_f32_bf16 v62, v221, v31, v62
    v_dot2_f32_bf16 v60, v218, v32, v60
    v_dot2_f32_bf16 v62, v222, v32, v62
    v_dot2_f32_bf16 v60, v219, v33, v60
    v_dot2_f32_bf16 v62, v223, v33, v62
    v_add_f32_dpp v61, v61, v61 row_ror:8 row_mask:0xf bank_mask:0x3
    v_add_f32_dpp v63, v63, v63 row_ror:8 row_mask:0xf bank_mask:0x3
    s_nop 0
    v_add_f32_dpp v61, v60, v60 row_ror:8 row_mask:0xf bank_mask:0xc
    v_add_f32_dpp v63, v62, v62 row_ror:8 row_mask:0xf bank_mask:0xc
    v_add_f32_dpp v52, v52, v52 row_half_mirror row_mask:0xf bank_mask:0x5
    v_add_f32_dpp v56, v56, v56 row_half_mirror row_mask:0xf bank_mask:0x5
    s_nop 0
    v_add_f32_dpp v52, v61, v61 row_half_mirror row_mask:0xf bank_mask:0xa
    v_add_f32_dpp v56, v63, v63 row_half_mirror row_mask:0xf bank_mask:0xa
    v_dot2_f32_bf16 v53, v224, v30, 0
    v_dot2_f32_bf16 v57, v228, v30, 0
    v_dot2_f32_bf16 v53, v225, v31, v53
    v_dot2_f32_bf16 v57, v229, v31, v57
    v_dot2_f32_bf16 v53, v226, v32, v53
    v_dot2_f32_bf16 v57, v230, v32, v57
    v_dot2_f32_bf16 v53, v227, v33, v53
    v_dot2_f32_bf16 v57, v231, v33, v57
    s_add_u32 s64, s73, 110080
    buffer_load_dwordx4 a[168:171], v5, s[48:51], s64 offen
    s_add_u32 s64, s73, 112832
    buffer_load_dwordx4 a[172:175], v5, s[48:51], s64 offen
    s_waitcnt vmcnt(10)
    v_dot2_f32_bf16 v60, v232, v30, 0
    v_dot2_f32_bf16 v62, v236, v30, 0
    v_dot2_f32_bf16 v60, v233, v31, v60
    v_dot2_f32_bf16 v62, v237, v31, v62
    v_dot2_f32_bf16 v60, v234, v32, v60
    v_dot2_f32_bf16 v62, v238, v32, v62
    v_dot2_f32_bf16 v60, v235, v33, v60
    v_dot2_f32_bf16 v62, v239, v33, v62
    v_add_f32_dpp v53, v53, v53 row_ror:8 row_mask:0xf bank_mask:0x3
    v_add_f32_dpp v57, v57, v57 row_ror:8 row_mask:0xf bank_mask:0x3
    s_nop 0
    v_add_f32_dpp v53, v60, v60 row_ror:8 row_mask:0xf bank_mask:0xc
    v_add_f32_dpp v57, v62, v62 row_ror:8 row_mask:0xf bank_mask:0xc
    v_dot2_f32_bf16 v61, v240, v30, 0
    v_dot2_f32_bf16 v63, v244, v30, 0
    v_dot2_f32_bf16 v61, v241, v31, v61
    v_dot2_f32_bf16 v63, v245, v31, v63
    v_dot2_f32_bf16 v61, v242, v32, v61
    v_dot2_f32_bf16 v63, v246, v32, v63
    v_dot2_f32_bf16 v61, v243, v33, v61
    v_dot2_f32_bf16 v63, v247, v33, v63
    v_dot2_f32_bf16 v60, v248, v30, 0
    v_dot2_f32_bf16 v62, v252, v30, 0
    v_dot2_f32_bf16 v60, v249, v31, v60
    v_dot2_f32_bf16 v62, v253, v31, v62
    v_dot2_f32_bf16 v60, v250, v32, v60
    v_dot2_f32_bf16 v62, v254, v32, v62
    v_dot2_f32_bf16 v60, v251, v33, v60
    v_dot2_f32_bf16 v62, v255, v33, v62
    v_add_f32_dpp v61, v61, v61 row_ror:8 row_mask:0xf bank_mask:0x3
    v_add_f32_dpp v63, v63, v63 row_ror:8 row_mask:0xf bank_mask:0x3
    s_nop 0
    v_add_f32_dpp v61, v60, v60 row_ror:8 row_mask:0xf bank_mask:0xc
    v_add_f32_dpp v63, v62, v62 row_ror:8 row_mask:0xf bank_mask:0xc
    v_add_f32_dpp v53, v53, v53 row_half_mirror row_mask:0xf bank_mask:0x5
    v_add_f32_dpp v57, v57, v57 row_half_mirror row_mask:0xf bank_mask:0x5
    s_nop 0
    v_add_f32_dpp v53, v61, v61 row_half_mirror row_mask:0xf bank_mask:0xa
    v_add_f32_dpp v57, v63, v63 row_half_mirror row_mask:0xf bank_mask:0xa
    s_mov_b32 s64, 245760
    buffer_load_dwordx4 v[112:115], v1, s[32:35], s64 offen nt
    buffer_load_dwordx4 v[116:119], v1, s[32:35], s64 offen offset:256 nt
    s_mov_b32 s64, 253952
    buffer_load_dwordx4 v[120:123], v1, s[32:35], s64 offen nt
    buffer_load_dwordx4 v[124:127], v1, s[32:35], s64 offen offset:256 nt
    s_waitcnt vmcnt(10)
    v_dot2_f32_bf16 v54, v64, v30, 0
    v_dot2_f32_bf16 v58, v68, v30, 0
    v_dot2_f32_bf16 v54, v65, v31, v54
    v_dot2_f32_bf16 v58, v69, v31, v58
    v_dot2_f32_bf16 v54, v66, v32, v54
    v_dot2_f32_bf16 v58, v70, v32, v58
    v_dot2_f32_bf16 v54, v67, v33, v54
    v_dot2_f32_bf16 v58, v71, v33, v58
    v_dot2_f32_bf16 v60, v72, v30, 0
    v_dot2_f32_bf16 v62, v76, v30, 0
    v_dot2_f32_bf16 v60, v73, v31, v60
    v_dot2_f32_bf16 v62, v77, v31, v62
    v_dot2_f32_bf16 v60, v74, v32, v60
    v_dot2_f32_bf16 v62, v78, v32, v62
    v_dot2_f32_bf16 v60, v75, v33, v60
    v_dot2_f32_bf16 v62, v79, v33, v62
    v_add_f32_dpp v54, v54, v54 row_ror:8 row_mask:0xf bank_mask:0x3
    v_add_f32_dpp v58, v58, v58 row_ror:8 row_mask:0xf bank_mask:0x3
    s_nop 0
    v_add_f32_dpp v54, v60, v60 row_ror:8 row_mask:0xf bank_mask:0xc
    v_add_f32_dpp v58, v62, v62 row_ror:8 row_mask:0xf bank_mask:0xc
    v_dot2_f32_bf16 v61, v80, v30, 0
    v_dot2_f32_bf16 v63, v84, v30, 0
    v_dot2_f32_bf16 v61, v81, v31, v61
    v_dot2_f32_bf16 v63, v85, v31, v63
    v_dot2_f32_bf16 v61, v82, v32, v61
    v_dot2_f32_bf16 v63, v86, v32, v63
    v_dot2_f32_bf16 v61, v83, v33, v61
    v_dot2_f32_bf16 v63, v87, v33, v63
    s_add_u32 s64, s73, 99072
    buffer_load_dwordx4 a[176:179], v5, s[48:51], s64 offen
    s_add_u32 s64, s73, 101824
    buffer_load_dwordx4 a[180:183], v5, s[48:51], s64 offen
    s_waitcnt vmcnt(10)
    v_dot2_f32_bf16 v60, v88, v30, 0
    v_dot2_f32_bf16 v62, v92, v30, 0
    v_dot2_f32_bf16 v60, v89, v31, v60
    v_dot2_f32_bf16 v62, v93, v31, v62
    v_dot2_f32_bf16 v60, v90, v32, v60
    v_dot2_f32_bf16 v62, v94, v32, v62
    v_dot2_f32_bf16 v60, v91, v33, v60
    v_dot2_f32_bf16 v62, v95, v33, v62
    v_add_f32_dpp v61, v61, v61 row_ror:8 row_mask:0xf bank_mask:0x3
    v_add_f32_dpp v63, v63, v63 row_ror:8 row_mask:0xf bank_mask:0x3
    s_nop 0
    v_add_f32_dpp v61, v60, v60 row_ror:8 row_mask:0xf bank_mask:0xc
    v_add_f32_dpp v63, v62, v62 row_ror:8 row_mask:0xf bank_mask:0xc
    v_add_f32_dpp v54, v54, v54 row_half_mirror row_mask:0xf bank_mask:0x5
    v_add_f32_dpp v58, v58, v58 row_half_mirror row_mask:0xf bank_mask:0x5
    s_nop 0
    v_add_f32_dpp v54, v61, v61 row_half_mirror row_mask:0xf bank_mask:0xa
    v_add_f32_dpp v58, v63, v63 row_half_mirror row_mask:0xf bank_mask:0xa
    v_dot2_f32_bf16 v55, v96, v30, 0
    v_dot2_f32_bf16 v59, v100, v30, 0
    v_dot2_f32_bf16 v55, v97, v31, v55
    v_dot2_f32_bf16 v59, v101, v31, v59
    v_dot2_f32_bf16 v55, v98, v32, v55
    v_dot2_f32_bf16 v59, v102, v32, v59
    v_dot2_f32_bf16 v55, v99, v33, v55
    v_dot2_f32_bf16 v59, v103, v33, v59
    s_mov_b32 s64, 0
    buffer_load_dwordx4 v[128:131], v2, s[36:39], s64 offen nt
    buffer_load_dwordx4 v[132:135], v2, s[36:39], s64 offen offset:1024 nt
    s_branch L_pg2
.p2align 12
L_pad2:
    s_branch L_touched
    s_nop 0
L_pg2:
    s_waitcnt vmcnt(10)
    v_dot2_f32_bf16 v60, v104, v30, 0
    v_dot2_f32_bf16 v62, v108, v30, 0
    v_dot2_f32_bf16 v60, v105, v31, v60
    v_dot2_f32_bf16 v62, v109, v31, v62
    v_dot2_f32_bf16 v60, v106, v32, v60
    v_dot2_f32_bf16 v62, v110, v32, v62
    v_dot2_f32_bf16 v60, v107, v33, v60
    v_dot2_f32_bf16 v62, v111, v33, v62
    v_add_f32_dpp v55, v55, v55 row_ror:8 row_mask:0xf bank_mask:0x3
    v_add_f32_dpp v59, v59, v59 row_ror:8 row_mask:0xf bank_mask:0x3
    s_nop 0
    v_add_f32_dpp v55, v60, v60 row_ror:8 row_mask:0xf bank_mask:0xc
    v_add_f32_dpp v59, v62, v62 row_ror:8 row_mask:0xf bank_mask:0xc
    s_mov_b32 s64, 8192
    buffer_load_dwordx4 v[136:139], v2, s[36:39], s64 offen nt
    buffer_load_dwordx4 v[140:143], v2, s[36:39], s64 offen offset:1024 nt
    s_waitcnt vmcnt(10)
    s_add_u32 s64, s73, 121088
    buffer_load_dwordx4 a[184:187], v5, s[48:51], s64 offen
    s_add_u32 s64, s73, 123840
    buffer_load_dwordx4 a[188:191], v5, s[48:51], s64 offen
    s_waitcnt vmcnt(10)
    v_dot2_f32_bf16 v61, v112, v30, 0
    v_dot2_f32_bf16 v63, v116, v30, 0
    v_dot2_f32_bf16 v61, v113, v31, v61
    v_dot2_f32_bf16 v63, v117, v31, v63
    v_dot2_f32_bf16 v61, v114, v32, v61
    v_dot2_f32_bf16 v63, v118, v32, v63
    v_dot2_f32_bf16 v61, v115, v33, v61
    v_dot2_f32_bf16 v63, v119, v33, v63
    s_mov_b32 s64, 16384
    buffer_load_dwordx4 v[144:147], v2, s[36:39], s64 offen nt
    buffer_load_dwordx4 v[148:151], v2, s[36:39], s64 offen offset:1024 nt
    s_waitcnt vmcnt(10)
    v_dot2_f32_bf16 v60, v120, v30, 0
    v_dot2_f32_bf16 v62, v124, v30, 0
    v_dot2_f32_bf16 v60, v121, v31, v60
    v_dot2_f32_bf16 v62, v125, v31, v62
    v_dot2_f32_bf16 v60, v122, v32, v60
    v_dot2_f32_bf16 v62, v126, v32, v62
    v_dot2_f32_bf16 v60, v123, v33, v60
    v_dot2_f32_bf16 v62, v127, v33, v62
    v_add_f32_dpp v61, v61, v61 row_ror:8 row_mask:0xf bank_mask:0x3
    v_add_f32_dpp v63, v63, v63 row_ror:8 row_mask:0xf bank_mask:0x3
    s_nop 0
    v_add_f32_dpp v61, v60, v60 row_ror:8 row_mask:0xf bank_mask:0xc
    v_add_f32_dpp v63, v62, v62 row_ror:8 row_mask:0xf bank_mask:0xc
    v_add_f32_dpp v55, v55, v55 row_half_mirror row_mask:0xf bank_mask:0x5
    v_add_f32_dpp v59, v59, v59 row_half_mirror row_mask:0xf bank_mask:0x5
    s_nop 0
    v_add_f32_dpp v55, v61, v61 row_half_mirror row_mask:0xf bank_mask:0xa
    v_add_f32_dpp v59, v63, v63 row_half_mirror row_mask:0xf bank_mask:0xa
    v_add_f32_dpp v52, v52, v52 quad_perm:[1,0,3,2] row_mask:0xf bank_mask:0xf
    v_add_f32_dpp v53, v53, v53 quad_perm:[1,0,3,2] row_mask:0xf bank_mask:0xf
    v_add_f32_dpp v54, v54, v54 quad_perm:[1,0,3,2] row_mask:0xf bank_mask:0xf
    v_add_f32_dpp v55, v55, v55 quad_perm:[1,0,3,2] row_mask:0xf bank_mask:0xf
    v_add_f32_dpp v56, v56, v56 quad_perm:[1,0,3,2] row_mask:0xf bank_mask:0xf
    v_add_f32_dpp v57, v57, v57 quad_perm:[1,0,3,2] row_mask:0xf bank_mask:0xf
    v_add_f32_dpp v58, v58, v58 quad_perm:[1,0,3,2] row_mask:0xf bank_mask:0xf
    v_add_f32_dpp v59, v59, v59 quad_perm:[1,0,3,2] row_mask:0xf bank_mask:0xf
    v_cndmask_b32 v52, v52, v53, s[76:77]
    v_cndmask_b32 v54, v54, v55, s[76:77]
    v_cndmask_b32 v56, v56, v57, s[76:77]
    v_cndmask_b32 v58, v58, v59, s[76:77]
    s_mov_b32 s64, 24576
    buffer_load_dwordx4 v[152:155], v2, s[36:39], s64 offen nt
    buffer_load_dwordx4 v[156:159], v2, s[36:39], s64 offen offset:1024 nt
    v_add_f32_dpp v52, v52, v52 quad_perm:[2,3,0,1] row_mask:0xf bank_mask:0xf
    v_add_f32_dpp v54, v54, v54 quad_perm:[2,3,0,1] row_mask:0xf bank_mask:0xf
    v_add_f32_dpp v56, v56, v56 quad_perm:[2,3,0,1] row_mask:0xf bank_mask:0xf
    v_add_f32_dpp v58, v58, v58 quad_perm:[2,3,0,1] row_mask:0xf bank_mask:0xf
    v_cndmask_b32 v50, v52, v54, s[78:79]
    v_cndmask_b32 v51, v56, v58, s[78:79]
    v_cvt_pk_bf16_f32 v49, v48, v49
    v_lshlrev_b32 v48, 16, v49
    v_and_b32 v49, 0xffff0000, v49
    v_cvt_pk_bf16_f32 v51, v50, v51
    v_lshlrev_b32 v50, 16, v51
    v_and_b32 v51, 0xffff0000, v51
    v_mul_f32 v48, 0x3db504f3, v48
    v_mul_f32 v49, 0x3db504f3, v49
    v_mul_f32 v50, 0x3db504f3, v50
    v_mul_f32 v51, 0x3db504f3, v51
    v_cvt_pk_bf16_f32 v49, v48, v49
    v_lshlrev_b32 v48, 16, v49
    v_and_b32 v49, 0xffff0000, v49
    v_cvt_pk_bf16_f32 v51, v50, v51
    v_lshlrev_b32 v50, 16, v51
    v_and_b32 v51, 0xffff0000, v51
    v_max_f32 v52, v48, v49
    v_max3_f32 v52, v52, v50, v51
    s_nop 1
    v_max_f32_dpp v52, v52, v52 row_ror:8 row_mask:0xf bank_mask:0xf
    s_nop 1
    v_max_f32_dpp v52, v52, v52 row_ror:4 row_mask:0xf bank_mask:0xf
    s_nop 1
    v_max_f32_dpp v52, v52, v52 row_ror:2 row_mask:0xf bank_mask:0xf
    s_nop 1
    v_max_f32_dpp v52, v52, v52 row_ror:1 row_mask:0xf bank_mask:0xf
    s_nop 1
    v_max_f32_dpp v52, v52, v52 row_bcast:15 row_mask:0xa bank_mask:0xf
    s_nop 1
    v_max_f32_dpp v52, v52, v52 row_bcast:31 row_mask:0xc bank_mask:0xf
    s_nop 0
    v_readlane_b32 s66, v52, 63
    s_nop 1
    v_subrev_f32 v52, s66, v48
    v_subrev_f32 v53, s66, v49
    v_subrev_f32 v54, s66, v50
    v_subrev_f32 v55, s66, v51
    v_mul_f32 v52, 0x3fb8aa3b, v52
    v_mul_f32 v53, 0x3fb8aa3b, v53
    v_mul_f32 v54, 0x3fb8aa3b, v54
    v_mul_f32 v55, 0x3fb8aa3b, v55
    v_exp_f32 v52, v52
    s_add_u32 s64, s75, 0
    buffer_load_dwordx4 v[160:163], v4, s[44:47], s64 offen
    buffer_load_dwordx4 v[164:167], v4, s[44:47], s64 offen offset:1024
    v_exp_f32 v53, v53
    v_exp_f32 v54, v54
    v_exp_f32 v55, v55
    v_add_f32 v52, v52, v53
    v_add_f32 v54, v54, v55
    v_add_f32 v52, v52, v54
    s_nop 1
    v_add_f32_dpp v52, v52, v52 row_ror:8 row_mask:0xf bank_mask:0xf
    s_nop 1
    v_add_f32_dpp v52, v52, v52 row_ror:4 row_mask:0xf bank_mask:0xf
    s_nop 1
    v_add_f32_dpp v52, v52, v52 row_ror:2 row_mask:0xf bank_mask:0xf
    s_nop 1
    v_add_f32_dpp v52, v52, v52 row_ror:1 row_mask:0xf bank_mask:0xf
    s_nop 1
    v_add_f32_dpp v52, v52, v52 row_bcast:15 row_mask:0xa bank_mask:0xf
    s_nop 1
    v_add_f32_dpp v52, v52, v52 row_bcast:31 row_mask:0xc bank_mask:0xf
    s_nop 0
    v_readlane_b32 s67, v52, 63
    v_mov_b32 v52, s66
    s_nop 0
    v_mov_b32 v53, s67
    v_lshlrev_b32 v54, 3, v13
    ds_write_b64 v54, v[52:53] offset:4096
    v_and_b32 v54, 3, v0
    v_lshlrev_b32 v54, 3, v54
    s_waitcnt lgkmcnt(0)
    s_barrier
    ds_read_b64 v[52:53], v54 offset:4096
    s_mov_b32 s64, 32768
    buffer_load_dwordx4 v[168:171], v2, s[36:39], s64 offen nt
    buffer_load_dwordx4 v[172:175], v2, s[36:39], s64 offen offset:1024 nt
    s_waitcnt lgkmcnt(0)
    v_max_f32_dpp v54, v52, v52 quad_perm:[1,0,3,2] row_mask:0xf bank_mask:0xf
    s_nop 1
    v_max_f32_dpp v54, v54, v54 quad_perm:[2,3,0,1] row_mask:0xf bank_mask:0xf
    v_sub_f32 v52, v52, v54
    v_sub_f32 v48, v48, v54
    v_sub_f32 v49, v49, v54
    v_sub_f32 v50, v50, v54
    v_sub_f32 v51, v51, v54
    v_mul_f32 v52, 0x3fb8aa3b, v52
    v_mul_f32 v48, 0x3fb8aa3b, v48
    v_mul_f32 v49, 0x3fb8aa3b, v49
    v_mul_f32 v50, 0x3fb8aa3b, v50
    v_mul_f32 v51, 0x3fb8aa3b, v51
    v_exp_f32 v52, v52
    v_exp_f32 v48, v48
    v_exp_f32 v49, v49
    v_exp_f32 v50, v50
    v_exp_f32 v51, v51
    v_mul_f32 v53, v53, v52
    s_nop 1
    v_add_f32_dpp v53, v53, v53 quad_perm:[1,0,3,2] row_mask:0xf bank_mask:0xf
    s_nop 1
    v_add_f32_dpp v53, v53, v53 quad_perm:[2,3,0,1] row_mask:0xf bank_mask:0xf
    s_add_u32 s64, s75, 8192
    buffer_load_dwordx4 v[176:179], v4, s[44:47], s64 offen
    buffer_load_dwordx4 v[180:183], v4, s[44:47], s64 offen offset:1024
    v_rcp_f32 v53, v53
    s_nop 0
    v_mul_f32 v48, v48, v53
    v_mul_f32 v49, v49, v53
    v_mul_f32 v50, v50, v53
    v_mul_f32 v51, v51, v53
    v_cvt_pk_bf16_f32 v48, v48, v49
    v_cvt_pk_bf16_f32 v49, v50, v51
    s_lshl_b32 s66, s30, 5
    v_mov_b32 v52, s66
    global_load_dword v26, v52, s[26:27] sc1
    v_lshl_add_u32 v53, v12, 2, v11
    s_lshl_b32 s66, s14, 3
    v_add_lshl_u32 v54, v53, s66, 1
    buffer_load_ushort v24, v54, s[60:63], 0 offen
    v_and_b32 v57, 1, v0
    v_lshlrev_b32 v53, 2, v11
    v_lshl_add_u32 v53, v57, 4, v53
    s_lshl_b32 s66, s31, 5
    v_add_u32 v50, s66, v53
    global_load_dword v25, v50, s[22:23]
    v_cmp_gt_u32 vcc, 8, v12
    v_mov_b32 v55, 0x3f80
    v_bfe_u32 v56, v0, 2, 1
    v_cndmask_b32 v30, 0, v55, vcc
    v_xor_b32 v31, v55, v30
    v_mov_b32 v32, v30
    v_mov_b32 v33, v31
    v_lshl_add_u32 v3, v56, 1, v57
    v_mul_u32_u24 v3, 0x5555, v3
    v_lshrrev_b32 v1, 1, v12
    v_lshl_add_u32 v1, v13, 3, v1
    v_mul_u32_u24 v1, 2176, v1
    v_lshl_add_u32 v1, v57, 4, v1
    v_lshl_add_u32 v1, v11, 3, v1
    v_and_b32 v23, 31, v0
    v_mul_u32_u24 v23, 2176, v23
    v_lshrrev_b32 v51, 1, v11
    v_lshl_add_u32 v51, v13, 1, v51
    v_lshlrev_b32 v51, 8, v51
    v_add_u32 v51, 4352, v51
    v_lshl_add_u32 v51, v29, 5, v51
    s_mov_b32 s64, 40960
    buffer_load_dwordx4 v[184:187], v2, s[36:39], s64 offen nt
    buffer_load_dwordx4 v[188:191], v2, s[36:39], s64 offen offset:1024 nt
    s_waitcnt vmcnt(13)
    v_and_b32_dpp v40, v48, v14 row_newbcast:0 row_mask:0xf bank_mask:0xf
    v_and_b32_dpp v41, v48, v15 row_newbcast:0 row_mask:0xf bank_mask:0xf
    v_and_b32_dpp v42, v48, v16 row_newbcast:0 row_mask:0xf bank_mask:0xf
    v_and_b32_dpp v43, v48, v17 row_newbcast:0 row_mask:0xf bank_mask:0xf
    s_nop 1
    v_smfmac_f32_16x16x64_bf16 v[36:39], v[40:43], v[128:135], v22
    v_and_b32_dpp v44, v48, v14 row_newbcast:8 row_mask:0xf bank_mask:0xf
    v_and_b32_dpp v45, v48, v15 row_newbcast:8 row_mask:0xf bank_mask:0xf
    v_and_b32_dpp v46, v48, v16 row_newbcast:8 row_mask:0xf bank_mask:0xf
    v_and_b32_dpp v47, v48, v17 row_newbcast:8 row_mask:0xf bank_mask:0xf
    s_nop 1
    v_smfmac_f32_16x16x64_bf16 v[36:39], v[44:47], v[136:143], v22
    v_and_b32_dpp v40, v48, v14 row_newbcast:4 row_mask:0xf bank_mask:0xf
    v_and_b32_dpp v41, v48, v15 row_newbcast:4 row_mask:0xf bank_mask:0xf
    v_and_b32_dpp v42, v48, v16 row_newbcast:4 row_mask:0xf bank_mask:0xf
    v_and_b32_dpp v43, v48, v17 row_newbcast:4 row_mask:0xf bank_mask:0xf
    s_nop 1
    v_smfmac_f32_16x16x64_bf16 v[36:39], v[40:43], v[144:151], v22
    s_mov_b32 s64, 49152
    buffer_load_dwordx4 v[192:195], v2, s[36:39], s64 offen nt
    buffer_load_dwordx4 v[196:199], v2, s[36:39], s64 offen offset:1024 nt
    s_waitcnt vmcnt(13)
    v_and_b32_dpp v44, v48, v14 row_newbcast:12 row_mask:0xf bank_mask:0xf
    v_and_b32_dpp v45, v48, v15 row_newbcast:12 row_mask:0xf bank_mask:0xf
    v_and_b32_dpp v46, v48, v16 row_newbcast:12 row_mask:0xf bank_mask:0xf
    v_and_b32_dpp v47, v48, v17 row_newbcast:12 row_mask:0xf bank_mask:0xf
    s_nop 1
    v_smfmac_f32_16x16x64_bf16 v[36:39], v[44:47], v[152:159], v22
    s_add_u32 s64, s75, 16384
    buffer_load_dwordx4 v[200:203], v4, s[44:47], s64 offen
    buffer_load_dwordx4 v[204:207], v4, s[44:47], s64 offen offset:1024
    s_waitcnt vmcnt(13)
    v_accvgpr_write_b32 a0, v160
    v_accvgpr_write_b32 a8, v161
    v_accvgpr_write_b32 a16, v162
    v_accvgpr_write_b32 a24, v163
    v_accvgpr_write_b32 a1, v164
    v_accvgpr_write_b32 a9, v165
    v_accvgpr_write_b32 a17, v166
    v_accvgpr_write_b32 a25, v167
    s_mov_b32 s64, 57344
    buffer_load_dwordx4 v[208:211], v2, s[36:39], s64 offen nt
    buffer_load_dwordx4 v[212:215], v2, s[36:39], s64 offen offset:1024 nt
    s_waitcnt vmcnt(13)
    v_and_b32_dpp v40, v48, v14 row_newbcast:1 row_mask:0xf bank_mask:0xf
    v_and_b32_dpp v41, v48, v15 row_newbcast:1 row_mask:0xf bank_mask:0xf
    v_and_b32_dpp v42, v48, v16 row_newbcast:1 row_mask:0xf bank_mask:0xf
    v_and_b32_dpp v43, v48, v17 row_newbcast:1 row_mask:0xf bank_mask:0xf
    s_nop 1
    v_smfmac_f32_16x16x64_bf16 v[36:39], v[40:43], v[168:175], v22
    s_mov_b32 s64, 65536
    buffer_load_dwordx4 v[216:219], v2, s[36:39], s64 offen nt
    buffer_load_dwordx4 v[220:223], v2, s[36:39], s64 offen offset:1024 nt
    s_waitcnt vmcnt(13)
    v_accvgpr_write_b32 a2, v176
    v_accvgpr_write_b32 a10, v177
    v_accvgpr_write_b32 a18, v178
    v_accvgpr_write_b32 a26, v179
    v_accvgpr_write_b32 a3, v180
    v_accvgpr_write_b32 a11, v181
    v_accvgpr_write_b32 a19, v182
    v_accvgpr_write_b32 a27, v183
    s_add_u32 s64, s75, 24576
    buffer_load_dwordx4 v[224:227], v4, s[44:47], s64 offen
    buffer_load_dwordx4 v[228:231], v4, s[44:47], s64 offen offset:1024
    s_waitcnt vmcnt(10)
    v_and_b32_dpp v44, v48, v14 row_newbcast:9 row_mask:0xf bank_mask:0xf
    v_and_b32_dpp v45, v48, v15 row_newbcast:9 row_mask:0xf bank_mask:0xf
    v_and_b32_dpp v46, v48, v16 row_newbcast:9 row_mask:0xf bank_mask:0xf
    v_and_b32_dpp v47, v48, v17 row_newbcast:9 row_mask:0xf bank_mask:0xf
    s_nop 1
    v_smfmac_f32_16x16x64_bf16 v[36:39], v[44:47], v[184:191], v22
    v_readfirstlane_b32 s66, v26
    s_nop 0
    s_cmp_ge_u32 s66, 32
    s_cbranch_scc1 L_cntok
    s_mov_b32 s72, 0
    s_lshl_b32 s66, s30, 5
    v_mov_b32 v52, s66
L_cntspin:
    global_load_dword v26, v52, s[26:27] sc1
    s_waitcnt vmcnt(0)
    v_readfirstlane_b32 s66, v26
    s_add_u32 s72, s72, 1
    s_cmp_gt_u32 s72, 0x40000
    s_cbranch_scc1 L_cntok
    s_sleep 4
    s_cmp_lt_u32 s66, 32
    s_cbranch_scc1 L_cntspin
L_cntok:
    s_mov_b32 s64, 73728
    buffer_load_dwordx4 v[232:235], v2, s[36:39], s64 offen nt
    buffer_load_dwordx4 v[236:239], v2, s[36:39], s64 offen offset:1024 nt
    s_waitcnt vmcnt(10)
    v_and_b32_dpp v40, v48, v14 row_newbcast:5 row_mask:0xf bank_mask:0xf
    v_and_b32_dpp v41, v48, v15 row_newbcast:5 row_mask:0xf bank_mask:0xf
    v_and_b32_dpp v42, v48, v16 row_newbcast:5 row_mask:0xf bank_mask:0xf
    v_and_b32_dpp v43, v48, v17 row_newbcast:5 row_mask:0xf bank_mask:0xf
    s_nop 1
    v_smfmac_f32_16x16x64_bf16 v[36:39], v[40:43], v[192:199], v22
    v_accvgpr_read_b32 v168, a128
    v_accvgpr_read_b32 v169, a129
    v_accvgpr_read_b32 v170, a130
    v_accvgpr_read_b32 v171, a131
    v_accvgpr_read_b32 v172, a132
    v_accvgpr_read_b32 v173, a133
    v_accvgpr_read_b32 v174, a134
    v_accvgpr_read_b32 v175, a135
    v_accvgpr_read_b32 v176, a136
    v_accvgpr_read_b32 v177, a137
    v_accvgpr_read_b32 v178, a138
    v_accvgpr_read_b32 v179, a139
    v_accvgpr_read_b32 v180, a140
    v_accvgpr_read_b32 v181, a141
    v_accvgpr_read_b32 v182, a142
    v_accvgpr_read_b32 v183, a143
    v_accvgpr_read_b32 v184, a144
    v_accvgpr_read_b32 v185, a145
    v_accvgpr_read_b32 v186, a146
    v_accvgpr_read_b32 v187, a147
    v_accvgpr_read_b32 v188, a148
    v_accvgpr_read_b32 v189, a149
    v_accvgpr_read_b32 v190, a150
    v_accvgpr_read_b32 v191, a151
    v_accvgpr_read_b32 v192, a152
    v_accvgpr_read_b32 v193, a153
    v_accvgpr_read_b32 v194, a154
    v_accvgpr_read_b32 v195, a155
    v_accvgpr_read_b32 v196, a156
    v_accvgpr_read_b32 v197, a157
    v_accvgpr_read_b32 v198, a158
    v_accvgpr_read_b32 v199, a159
    v_accvgpr_write_b32 a128, v168
    v_accvgpr_write_b32 a136, v169
    v_accvgpr_write_b32 a144, v170
    v_accvgpr_write_b32 a152, v171
    v_accvgpr_write_b32 a129, v172
    v_accvgpr_write_b32 a137, v173
    v_accvgpr_write_b32 a145, v174
    v_accvgpr_write_b32 a153, v175
    v_accvgpr_write_b32 a130, v176
    v_accvgpr_write_b32 a138, v177
    v_accvgpr_write_b32 a146, v178
    v_accvgpr_write_b32 a154, v179
    v_accvgpr_write_b32 a131, v180
    v_accvgpr_write_b32 a139, v181
    v_accvgpr_write_b32 a147, v182
    v_accvgpr_write_b32 a155, v183
    v_accvgpr_write_b32 a132, v184
    v_accvgpr_write_b32 a140, v185
    v_accvgpr_write_b32 a148, v186
    v_accvgpr_write_b32 a156, v187
    v_accvgpr_write_b32 a133, v188
    v_accvgpr_write_b32 a141, v189
    v_accvgpr_write_b32 a149, v190
    s_mov_b32 s64, 81920
    buffer_load_dwordx4 v[240:243], v2, s[36:39], s64 offen nt
    buffer_load_dwordx4 v[244:247], v2, s[36:39], s64 offen offset:1024 nt
    v_accvgpr_write_b32 a157, v191
    v_accvgpr_write_b32 a134, v192
    v_accvgpr_write_b32 a142, v193
    v_accvgpr_write_b32 a150, v194
    v_accvgpr_write_b32 a158, v195
    v_accvgpr_write_b32 a135, v196
    v_accvgpr_write_b32 a143, v197
    v_accvgpr_write_b32 a151, v198
    v_accvgpr_write_b32 a159, v199
    v_accvgpr_read_b32 v168, a160
    v_accvgpr_read_b32 v169, a161
    v_accvgpr_read_b32 v170, a162
    v_accvgpr_read_b32 v171, a163
    v_accvgpr_read_b32 v172, a164
    v_accvgpr_read_b32 v173, a165
    v_accvgpr_read_b32 v174, a166
    v_accvgpr_read_b32 v175, a167
    v_accvgpr_read_b32 v176, a168
    v_accvgpr_read_b32 v177, a169
    v_accvgpr_read_b32 v178, a170
    v_accvgpr_read_b32 v179, a171
    v_accvgpr_read_b32 v180, a172
    v_accvgpr_read_b32 v181, a173
    v_accvgpr_read_b32 v182, a174
    v_accvgpr_read_b32 v183, a175
    v_accvgpr_read_b32 v184, a176
    v_accvgpr_read_b32 v185, a177
    v_accvgpr_read_b32 v186, a178
    v_accvgpr_read_b32 v187, a179
    v_accvgpr_read_b32 v188, a180
    v_accvgpr_read_b32 v189, a181
    v_accvgpr_read_b32 v190, a182
    v_accvgpr_read_b32 v191, a183
    v_accvgpr_read_b32 v192, a184
    v_accvgpr_read_b32 v193, a185
    v_accvgpr_read_b32 v194, a186
    v_accvgpr_read_b32 v195, a187
    v_accvgpr_read_b32 v196, a188
    v_accvgpr_read_b32 v197, a189
    v_accvgpr_read_b32 v198, a190
    v_accvgpr_read_b32 v199, a191
    v_accvgpr_write_b32 a160, v168
    v_accvgpr_write_b32 a168, v169
    v_accvgpr_write_b32 a176, v170
    v_accvgpr_write_b32 a184, v171
    v_accvgpr_write_b32 a161, v172
    v_accvgpr_write_b32 a169, v173
    v_accvgpr_write_b32 a177, v174
    v_accvgpr_write_b32 a185, v175
    v_accvgpr_write_b32 a162, v176
    v_accvgpr_write_b32 a170, v177
    v_accvgpr_write_b32 a178, v178
    v_accvgpr_write_b32 a186, v179
    v_accvgpr_write_b32 a163, v180
    v_accvgpr_write_b32 a171, v181
    v_accvgpr_write_b32 a179, v182
    v_accvgpr_write_b32 a187, v183
    v_accvgpr_write_b32 a164, v184
    v_accvgpr_write_b32 a172, v185
    v_accvgpr_write_b32 a180, v186
    s_add_u32 s64, s75, 32768
    buffer_load_dwordx4 v[248:251], v4, s[44:47], s64 offen
    buffer_load_dwordx4 v[252:255], v4, s[44:47], s64 offen offset:1024
    v_accvgpr_write_b32 a188, v187
    v_accvgpr_write_b32 a165, v188
    v_accvgpr_write_b32 a173, v189
    v_accvgpr_write_b32 a181, v190
    v_accvgpr_write_b32 a189, v191
    v_accvgpr_write_b32 a166, v192
    v_accvgpr_write_b32 a174, v193
    v_accvgpr_write_b32 a182, v194
    v_accvgpr_write_b32 a190, v195
    v_accvgpr_write_b32 a167, v196
    v_accvgpr_write_b32 a175, v197
    v_accvgpr_write_b32 a183, v198
    v_accvgpr_write_b32 a191, v199
    v_mov_b32 v52, 0x3f803f80
    v_mov_b32 v53, 0x3f803f80
    v_mov_b32 v54, 0x3f803f80
    v_mov_b32 v55, 0x3f803f80
    v_mov_b32 v168, 0
    v_mov_b32 v169, 0
    v_mov_b32 v170, 0
    v_mov_b32 v171, 0
    v_mov_b32 v172, 0
    v_mov_b32 v173, 0
    v_mov_b32 v174, 0
    v_mov_b32 v175, 0
    v_mov_b32 v176, 0
    v_mov_b32 v177, 0
    v_mov_b32 v178, 0
    v_mov_b32 v179, 0
    v_mov_b32 v180, 0
    v_mov_b32 v181, 0
    v_mov_b32 v182, 0
    v_mov_b32 v183, 0
    v_smfmac_f32_16x16x64_bf16 v[168:171], v[52:55], a[128:135], v18
    v_smfmac_f32_16x16x64_bf16 v[172:175], v[52:55], a[136:143], v18
    v_smfmac_f32_16x16x64_bf16 v[176:179], v[52:55], a[144:151], v18
    v_smfmac_f32_16x16x64_bf16 v[180:183], v[52:55], a[152:159], v18
    v_smfmac_f32_16x16x64_bf16 v[168:171], v[52:55], a[160:167], v18
    v_smfmac_f32_16x16x64_bf16 v[172:175], v[52:55], a[168:175], v18
    v_smfmac_f32_16x16x64_bf16 v[176:179], v[52:55], a[176:183], v18
    v_smfmac_f32_16x16x64_bf16 v[180:183], v[52:55], a[184:191], v18
    v_add_u32 v56, 2048, v51
    s_mov_b32 exec_lo, 0x000000ff
    s_mov_b32 exec_hi, 0x0000ff00
    s_nop 2
    ds_write2_b64 v56, v[168:169], v[172:173] offset0:0 offset1:1
    s_nop 0
    ds_write2_b64 v56, v[176:177], v[180:181] offset0:2 offset1:3
    s_mov_b64 exec, -1
    s_waitcnt lgkmcnt(0)
    s_mov_b32 s64, 90112
    buffer_load_dwordx4 v[64:67], v2, s[36:39], s64 offen nt
    buffer_load_dwordx4 v[68:71], v2, s[36:39], s64 offen offset:1024 nt
    s_waitcnt vmcnt(10)
    v_and_b32_dpp v44, v48, v14 row_newbcast:13 row_mask:0xf bank_mask:0xf
    v_and_b32_dpp v45, v48, v15 row_newbcast:13 row_mask:0xf bank_mask:0xf
    v_and_b32_dpp v46, v48, v16 row_newbcast:13 row_mask:0xf bank_mask:0xf
    v_and_b32_dpp v47, v48, v17 row_newbcast:13 row_mask:0xf bank_mask:0xf
    s_nop 1
    v_smfmac_f32_16x16x64_bf16 v[36:39], v[44:47], v[208:215], v22
    v_and_b32_dpp v40, v48, v14 row_newbcast:2 row_mask:0xf bank_mask:0xf
    v_and_b32_dpp v41, v48, v15 row_newbcast:2 row_mask:0xf bank_mask:0xf
    v_and_b32_dpp v42, v48, v16 row_newbcast:2 row_mask:0xf bank_mask:0xf
    v_and_b32_dpp v43, v48, v17 row_newbcast:2 row_mask:0xf bank_mask:0xf
    s_nop 1
    v_smfmac_f32_16x16x64_bf16 v[36:39], v[40:43], v[216:223], v22
    v_accvgpr_write_b32 a4, v200
    v_accvgpr_write_b32 a12, v201
    v_accvgpr_write_b32 a20, v202
    v_accvgpr_write_b32 a28, v203
    v_accvgpr_write_b32 a5, v204
    v_accvgpr_write_b32 a13, v205
    v_accvgpr_write_b32 a21, v206
    v_accvgpr_write_b32 a29, v207
    s_mov_b32 s64, 98304
    buffer_load_dwordx4 v[72:75], v2, s[36:39], s64 offen nt
    buffer_load_dwordx4 v[76:79], v2, s[36:39], s64 offen offset:1024 nt
    s_waitcnt vmcnt(10)
    v_accvgpr_write_b32 a6, v224
    v_accvgpr_write_b32 a14, v225
    v_accvgpr_write_b32 a22, v226
    v_accvgpr_write_b32 a30, v227
    v_accvgpr_write_b32 a7, v228
    v_accvgpr_write_b32 a15, v229
    v_accvgpr_write_b32 a23, v230
    v_accvgpr_write_b32 a31, v231
    s_add_u32 s64, s75, 40960
    buffer_load_dwordx4 v[80:83], v4, s[44:47], s64 offen
    buffer_load_dwordx4 v[84:87], v4, s[44:47], s64 offen offset:1024
    s_branch L_pg3
.p2align 12
L_pad3:
    s_branch L_touched
    s_nop 0
L_pg3:
    s_waitcnt vmcnt(10)
    v_and_b32_dpp v44, v48, v14 row_newbcast:10 row_mask:0xf bank_mask:0xf
    v_and_b32_dpp v45, v48, v15 row_newbcast:10 row_mask:0xf bank_mask:0xf
    v_and_b32_dpp v46, v48, v16 row_newbcast:10 row_mask:0xf bank_mask:0xf
    v_and_b32_dpp v47, v48, v17 row_newbcast:10 row_mask:0xf bank_mask:0xf
    s_nop 1
    v_smfmac_f32_16x16x64_bf16 v[36:39], v[44:47], v[232:239], v22
    s_mov_b32 s64, 106496
    buffer_load_dwordx4 v[88:91], v2, s[36:39], s64 offen nt
    buffer_load_dwordx4 v[92:95], v2, s[36:39], s64 offen offset:1024 nt
    s_waitcnt vmcnt(10)
    v_and_b32_dpp v40, v48, v14 row_newbcast:6 row_mask:0xf bank_mask:0xf
    v_and_b32_dpp v41, v48, v15 row_newbcast:6 row_mask:0xf bank_mask:0xf
    v_and_b32_dpp v42, v48, v16 row_newbcast:6 row_mask:0xf bank_mask:0xf
    v_and_b32_dpp v43, v48, v17 row_newbcast:6 row_mask:0xf bank_mask:0xf
    s_nop 1
    v_smfmac_f32_16x16x64_bf16 v[36:39], v[40:43], v[240:247], v22
    s_add_u32 s64, s75, 49152
    buffer_load_dwordx4 v[96:99], v4, s[44:47], s64 offen
    buffer_load_dwordx4 v[100:103], v4, s[44:47], s64 offen offset:1024
    s_waitcnt vmcnt(10)
    v_accvgpr_write_b32 a32, v248
    v_accvgpr_write_b32 a40, v249
    v_accvgpr_write_b32 a48, v250
    v_accvgpr_write_b32 a56, v251
    v_accvgpr_write_b32 a33, v252
    v_accvgpr_write_b32 a41, v253
    v_accvgpr_write_b32 a49, v254
    v_accvgpr_write_b32 a57, v255
    s_mov_b32 s64, 114688
    buffer_load_dwordx4 v[104:107], v2, s[36:39], s64 offen nt
    buffer_load_dwordx4 v[108:111], v2, s[36:39], s64 offen offset:1024 nt
    s_waitcnt vmcnt(10)
    v_and_b32_dpp v44, v48, v14 row_newbcast:14 row_mask:0xf bank_mask:0xf
    v_and_b32_dpp v45, v48, v15 row_newbcast:14 row_mask:0xf bank_mask:0xf
    v_and_b32_dpp v46, v48, v16 row_newbcast:14 row_mask:0xf bank_mask:0xf
    v_and_b32_dpp v47, v48, v17 row_newbcast:14 row_mask:0xf bank_mask:0xf
    s_nop 1
    v_smfmac_f32_16x16x64_bf16 v[36:39], v[44:47], v[64:71], v22
    s_mov_b32 s64, 122880
    buffer_load_dwordx4 v[112:115], v2, s[36:39], s64 offen nt
    buffer_load_dwordx4 v[116:119], v2, s[36:39], s64 offen offset:1024 nt
    s_waitcnt vmcnt(10)
    v_and_b32_dpp v40, v48, v14 row_newbcast:3 row_mask:0xf bank_mask:0xf
    v_and_b32_dpp v41, v48, v15 row_newbcast:3 row_mask:0xf bank_mask:0xf
    v_and_b32_dpp v42, v48, v16 row_newbcast:3 row_mask:0xf bank_mask:0xf
    v_and_b32_dpp v43, v48, v17 row_newbcast:3 row_mask:0xf bank_mask:0xf
    s_nop 1
    v_smfmac_f32_16x16x64_bf16 v[36:39], v[40:43], v[72:79], v22
    s_add_u32 s64, s75, 57344
    buffer_load_dwordx4 v[120:123], v4, s[44:47], s64 offen
    buffer_load_dwordx4 v[124:127], v4, s[44:47], s64 offen offset:1024
    s_waitcnt vmcnt(10)
    v_accvgpr_write_b32 a34, v80
    v_accvgpr_write_b32 a42, v81
    v_accvgpr_write_b32 a50, v82
    v_accvgpr_write_b32 a58, v83
    v_accvgpr_write_b32 a35, v84
    v_accvgpr_write_b32 a43, v85
    v_accvgpr_write_b32 a51, v86
    v_accvgpr_write_b32 a59, v87
    s_mov_b32 s64, 131072
    buffer_load_dwordx4 v[128:131], v2, s[36:39], s64 offen nt
    buffer_load_dwordx4 v[132:135], v2, s[36:39], s64 offen offset:1024 nt
    s_waitcnt vmcnt(10)
    v_and_b32_dpp v44, v48, v14 row_newbcast:11 row_mask:0xf bank_mask:0xf
    v_and_b32_dpp v45, v48, v15 row_newbcast:11 row_mask:0xf bank_mask:0xf
    v_and_b32_dpp v46, v48, v16 row_newbcast:11 row_mask:0xf bank_mask:0xf
    v_and_b32_dpp v47, v48, v17 row_newbcast:11 row_mask:0xf bank_mask:0xf
    s_nop 1
    v_smfmac_f32_16x16x64_bf16 v[36:39], v[44:47], v[88:95], v22
    s_mov_b32 s64, 139264
    buffer_load_dwordx4 v[136:139], v2, s[36:39], s64 offen nt
    buffer_load_dwordx4 v[140:143], v2, s[36:39], s64 offen offset:1024 nt
    s_waitcnt vmcnt(10)
    v_accvgpr_write_b32 a36, v96
    v_accvgpr_write_b32 a44, v97
    v_accvgpr_write_b32 a52, v98
    v_accvgpr_write_b32 a60, v99
    v_accvgpr_write_b32 a37, v100
    v_accvgpr_write_b32 a45, v101
    v_accvgpr_write_b32 a53, v102
    v_accvgpr_write_b32 a61, v103
    s_add_u32 s64, s75, 65536
    buffer_load_dwordx4 v[144:147], v4, s[44:47], s64 offen
    buffer_load_dwordx4 v[148:151], v4, s[44:47], s64 offen offset:1024
    s_waitcnt vmcnt(10)
    v_and_b32_dpp v40, v48, v14 row_newbcast:7 row_mask:0xf bank_mask:0xf
    v_and_b32_dpp v41, v48, v15 row_newbcast:7 row_mask:0xf bank_mask:0xf
    v_and_b32_dpp v42, v48, v16 row_newbcast:7 row_mask:0xf bank_mask:0xf
    v_and_b32_dpp v43, v48, v17 row_newbcast:7 row_mask:0xf bank_mask:0xf
    s_nop 1
    v_smfmac_f32_16x16x64_bf16 v[36:39], v[40:43], v[104:111], v22
    s_mov_b32 s64, 147456
    buffer_load_dwordx4 v[152:155], v2, s[36:39], s64 offen nt
    buffer_load_dwordx4 v[156:159], v2, s[36:39], s64 offen offset:1024 nt
    s_waitcnt vmcnt(10)
    v_and_b32_dpp v44, v48, v14 row_newbcast:15 row_mask:0xf bank_mask:0xf
    v_and_b32_dpp v45, v48, v15 row_newbcast:15 row_mask:0xf bank_mask:0xf
    v_and_b32_dpp v46, v48, v16 row_newbcast:15 row_mask:0xf bank_mask:0xf
    v_and_b32_dpp v47, v48, v17 row_newbcast:15 row_mask:0xf bank_mask:0xf
    s_nop 1
    v_smfmac_f32_16x16x64_bf16 v[36:39], v[44:47], v[112:119], v22
    s_mov_b32 s64, 155648
    buffer_load_dwordx4 v[160:163], v2, s[36:39], s64 offen nt
    buffer_load_dwordx4 v[164:167], v2, s[36:39], s64 offen offset:1024 nt
    s_waitcnt vmcnt(10)
    v_accvgpr_write_b32 a38, v120
    v_accvgpr_write_b32 a46, v121
    v_accvgpr_write_b32 a54, v122
    v_accvgpr_write_b32 a62, v123
    v_accvgpr_write_b32 a39, v124
    v_accvgpr_write_b32 a47, v125
    v_accvgpr_write_b32 a55, v126
    v_accvgpr_write_b32 a63, v127
    s_add_u32 s64, s75, 73728
    buffer_load_dwordx4 v[168:171], v4, s[44:47], s64 offen
    buffer_load_dwordx4 v[172:175], v4, s[44:47], s64 offen offset:1024
    s_waitcnt vmcnt(10)
    v_and_b32_dpp v40, v49, v14 row_newbcast:0 row_mask:0xf bank_mask:0xf
    v_and_b32_dpp v41, v49, v15 row_newbcast:0 row_mask:0xf bank_mask:0xf
    v_and_b32_dpp v42, v49, v16 row_newbcast:0 row_mask:0xf bank_mask:0xf
    v_and_b32_dpp v43, v49, v17 row_newbcast:0 row_mask:0xf bank_mask:0xf
    s_nop 1
    v_smfmac_f32_16x16x64_bf16 v[36:39], v[40:43], v[128:135], v22
    s_mov_b32 s64, 163840
    buffer_load_dwordx4 v[176:179], v2, s[36:39], s64 offen nt
    buffer_load_dwordx4 v[180:183], v2, s[36:39], s64 offen offset:1024 nt
    s_waitcnt vmcnt(10)
    v_and_b32_dpp v44, v49, v14 row_newbcast:8 row_mask:0xf bank_mask:0xf
    v_and_b32_dpp v45, v49, v15 row_newbcast:8 row_mask:0xf bank_mask:0xf
    v_and_b32_dpp v46, v49, v16 row_newbcast:8 row_mask:0xf bank_mask:0xf
    v_and_b32_dpp v47, v49, v17 row_newbcast:8 row_mask:0xf bank_mask:0xf
    s_nop 1
    v_smfmac_f32_16x16x64_bf16 v[36:39], v[44:47], v[136:143], v22
    s_mov_b32 s64, 172032
    buffer_load_dwordx4 v[184:187], v2, s[36:39], s64 offen nt
    buffer_load_dwordx4 v[188:191], v2, s[36:39], s64 offen offset:1024 nt
    s_waitcnt vmcnt(10)
    v_accvgpr_write_b32 a64, v144
    v_accvgpr_write_b32 a72, v145
    v_accvgpr_write_b32 a80, v146
    v_accvgpr_write_b32 a88, v147
    v_accvgpr_write_b32 a65, v148
    v_accvgpr_write_b32 a73, v149
    v_accvgpr_write_b32 a81, v150
    v_accvgpr_write_b32 a89, v151
    s_add_u32 s64, s75, 81920
    buffer_load_dwordx4 v[192:195], v4, s[44:47], s64 offen
    buffer_load_dwordx4 v[196:199], v4, s[44:47], s64 offen offset:1024
    s_waitcnt vmcnt(10)
    v_and_b32_dpp v40, v49, v14 row_newbcast:4 row_mask:0xf bank_mask:0xf
    v_and_b32_dpp v41, v49, v15 row_newbcast:4 row_mask:0xf bank_mask:0xf
    v_and_b32_dpp v42, v49, v16 row_newbcast:4 row_mask:0xf bank_mask:0xf
    v_and_b32_dpp v43, v49, v17 row_newbcast:4 row_mask:0xf bank_mask:0xf
    s_nop 1
    v_smfmac_f32_16x16x64_bf16 v[36:39], v[40:43], v[152:159], v22
    s_mov_b32 s64, 180224
    buffer_load_dwordx4 v[200:203], v2, s[36:39], s64 offen nt
    buffer_load_dwordx4 v[204:207], v2, s[36:39], s64 offen offset:1024 nt
    s_waitcnt vmcnt(10)
    v_and_b32_dpp v44, v49, v14 row_newbcast:12 row_mask:0xf bank_mask:0xf
    v_and_b32_dpp v45, v49, v15 row_newbcast:12 row_mask:0xf bank_mask:0xf
    v_and_b32_dpp v46, v49, v16 row_newbcast:12 row_mask:0xf bank_mask:0xf
    v_and_b32_dpp v47, v49, v17 row_newbcast:12 row_mask:0xf bank_mask:0xf
    s_nop 1
    v_smfmac_f32_16x16x64_bf16 v[36:39], v[44:47], v[160:167], v22
    s_add_u32 s64, s75, 90112
    buffer_load_dwordx4 v[208:211], v4, s[44:47], s64 offen
    buffer_load_dwordx4 v[212:215], v4, s[44:47], s64 offen offset:1024
    s_waitcnt vmcnt(10)
    v_accvgpr_write_b32 a66, v168
    v_accvgpr_write_b32 a74, v169
    v_accvgpr_write_b32 a82, v170
    v_accvgpr_write_b32 a90, v171
    v_accvgpr_write_b32 a67, v172
    v_accvgpr_write_b32 a75, v173
    v_accvgpr_write_b32 a83, v174
    v_accvgpr_write_b32 a91, v175
    s_mov_b32 s64, 188416
    buffer_load_dwordx4 v[216:219], v2, s[36:39], s64 offen nt
    buffer_load_dwordx4 v[220:223], v2, s[36:39], s64 offen offset:1024 nt
    s_waitcnt vmcnt(10)
    v_and_b32_dpp v40, v49, v14 row_newbcast:1 row_mask:0xf bank_mask:0xf
    v_and_b32_dpp v41, v49, v15 row_newbcast:1 row_mask:0xf bank_mask:0xf
    v_and_b32_dpp v42, v49, v16 row_newbcast:1 row_mask:0xf bank_mask:0xf
    v_and_b32_dpp v43, v49, v17 row_newbcast:1 row_mask:0xf bank_mask:0xf
    s_nop 1
    v_smfmac_f32_16x16x64_bf16 v[36:39], v[40:43], v[176:183], v22
    s_mov_b32 s64, 196608
    buffer_load_dwordx4 v[224:227], v2, s[36:39], s64 offen nt
    buffer_load_dwordx4 v[228:231], v2, s[36:39], s64 offen offset:1024 nt
    s_waitcnt vmcnt(10)
    v_and_b32_dpp v44, v49, v14 row_newbcast:9 row_mask:0xf bank_mask:0xf
    v_and_b32_dpp v45, v49, v15 row_newbcast:9 row_mask:0xf bank_mask:0xf
    v_and_b32_dpp v46, v49, v16 row_newbcast:9 row_mask:0xf bank_mask:0xf
    v_and_b32_dpp v47, v49, v17 row_newbcast:9 row_mask:0xf bank_mask:0xf
    s_nop 1
    v_smfmac_f32_16x16x64_bf16 v[36:39], v[44:47], v[184:191], v22
    s_add_u32 s64, s75, 98304
    buffer_load_dwordx4 v[232:235], v4, s[44:47], s64 offen
    buffer_load_dwordx4 v[236:239], v4, s[44:47], s64 offen offset:1024
    s_waitcnt vmcnt(10)
    v_accvgpr_write_b32 a68, v192
    v_accvgpr_write_b32 a76, v193
    v_accvgpr_write_b32 a84, v194
    v_accvgpr_write_b32 a92, v195
    v_accvgpr_write_b32 a69, v196
    v_accvgpr_write_b32 a77, v197
    v_accvgpr_write_b32 a85, v198
    v_accvgpr_write_b32 a93, v199
    s_mov_b32 s64, 204800
    buffer_load_dwordx4 v[240:243], v2, s[36:39], s64 offen nt
    buffer_load_dwordx4 v[244:247], v2, s[36:39], s64 offen offset:1024 nt
    s_waitcnt vmcnt(10)
    v_and_b32_dpp v40, v49, v14 row_newbcast:5 row_mask:0xf bank_mask:0xf
    v_and_b32_dpp v41, v49, v15 row_newbcast:5 row_mask:0xf bank_mask:0xf
    v_and_b32_dpp v42, v49, v16 row_newbcast:5 row_mask:0xf bank_mask:0xf
    v_and_b32_dpp v43, v49, v17 row_newbcast:5 row_mask:0xf bank_mask:0xf
    s_nop 1
    v_smfmac_f32_16x16x64_bf16 v[36:39], v[40:43], v[200:207], v22
    s_mov_b32 s64, 212992
    buffer_load_dwordx4 v[248:251], v2, s[36:39], s64 offen nt
    buffer_load_dwordx4 v[252:255], v2, s[36:39], s64 offen offset:1024 nt
    s_waitcnt vmcnt(10)
    v_accvgpr_write_b32 a70, v208
    v_accvgpr_write_b32 a78, v209
    v_accvgpr_write_b32 a86, v210
    v_accvgpr_write_b32 a94, v211
    v_accvgpr_write_b32 a71, v212
    v_accvgpr_write_b32 a79, v213
    v_accvgpr_write_b32 a87, v214
    v_accvgpr_write_b32 a95, v215
    s_add_u32 s64, s75, 106496
    buffer_load_dwordx4 v[64:67], v4, s[44:47], s64 offen
    buffer_load_dwordx4 v[68:71], v4, s[44:47], s64 offen offset:1024
    s_waitcnt vmcnt(10)
    v_and_b32_dpp v44, v49, v14 row_newbcast:13 row_mask:0xf bank_mask:0xf
    v_and_b32_dpp v45, v49, v15 row_newbcast:13 row_mask:0xf bank_mask:0xf
    v_and_b32_dpp v46, v49, v16 row_newbcast:13 row_mask:0xf bank_mask:0xf
    v_and_b32_dpp v47, v49, v17 row_newbcast:13 row_mask:0xf bank_mask:0xf
    s_nop 1
    v_smfmac_f32_16x16x64_bf16 v[36:39], v[44:47], v[216:223], v22
    s_mov_b32 s64, 221184
    buffer_load_dwordx4 v[72:75], v2, s[36:39], s64 offen nt
    buffer_load_dwordx4 v[76:79], v2, s[36:39], s64 offen offset:1024 nt
    s_waitcnt vmcnt(10)
    v_and_b32_dpp v40, v49, v14 row_newbcast:2 row_mask:0xf bank_mask:0xf
    v_and_b32_dpp v41, v49, v15 row_newbcast:2 row_mask:0xf bank_mask:0xf
    v_and_b32_dpp v42, v49, v16 row_newbcast:2 row_mask:0xf bank_mask:0xf
    v_and_b32_dpp v43, v49, v17 row_newbcast:2 row_mask:0xf bank_mask:0xf
    s_nop 1
    v_smfmac_f32_16x16x64_bf16 v[36:39], v[40:43], v[224:231], v22
    s_mov_b32 s64, 229376
    buffer_load_dwordx4 v[80:83], v2, s[36:39], s64 offen nt
    buffer_load_dwordx4 v[84:87], v2, s[36:39], s64 offen offset:1024 nt
    s_waitcnt vmcnt(10)
    v_accvgpr_write_b32 a96, v232
    v_accvgpr_write_b32 a104, v233
    v_accvgpr_write_b32 a112, v234
    v_accvgpr_write_b32 a120, v235
    v_accvgpr_write_b32 a97, v236
    v_accvgpr_write_b32 a105, v237
    v_accvgpr_write_b32 a113, v238
    v_accvgpr_write_b32 a121, v239
    s_add_u32 s64, s75, 114688
    buffer_load_dwordx4 v[88:91], v4, s[44:47], s64 offen
    buffer_load_dwordx4 v[92:95], v4, s[44:47], s64 offen offset:1024
    s_waitcnt vmcnt(10)
    v_and_b32_dpp v44, v49, v14 row_newbcast:10 row_mask:0xf bank_mask:0xf
    v_and_b32_dpp v45, v49, v15 row_newbcast:10 row_mask:0xf bank_mask:0xf
    v_and_b32_dpp v46, v49, v16 row_newbcast:10 row_mask:0xf bank_mask:0xf
    v_and_b32_dpp v47, v49, v17 row_newbcast:10 row_mask:0xf bank_mask:0xf
    s_nop 1
    v_smfmac_f32_16x16x64_bf16 v[36:39], v[44:47], v[240:247], v22
    s_mov_b32 s64, 237568
    buffer_load_dwordx4 v[96:99], v2, s[36:39], s64 offen nt
    buffer_load_dwordx4 v[100:103], v2, s[36:39], s64 offen offset:1024 nt
    s_waitcnt vmcnt(10)
    v_and_b32_dpp v40, v49, v14 row_newbcast:6 row_mask:0xf bank_mask:0xf
    v_and_b32_dpp v41, v49, v15 row_newbcast:6 row_mask:0xf bank_mask:0xf
    v_and_b32_dpp v42, v49, v16 row_newbcast:6 row_mask:0xf bank_mask:0xf
    v_and_b32_dpp v43, v49, v17 row_newbcast:6 row_mask:0xf bank_mask:0xf
    s_nop 1
    v_smfmac_f32_16x16x64_bf16 v[36:39], v[40:43], v[248:255], v22
    s_add_u32 s64, s75, 122880
    buffer_load_dwordx4 v[104:107], v4, s[44:47], s64 offen
    buffer_load_dwordx4 v[108:111], v4, s[44:47], s64 offen offset:1024
    s_waitcnt vmcnt(10)
    v_accvgpr_write_b32 a98, v64
    v_accvgpr_write_b32 a106, v65
    v_accvgpr_write_b32 a114, v66
    v_accvgpr_write_b32 a122, v67
    v_accvgpr_write_b32 a99, v68
    v_accvgpr_write_b32 a107, v69
    v_accvgpr_write_b32 a115, v70
    v_accvgpr_write_b32 a123, v71
    s_mov_b32 s64, 245760
    buffer_load_dwordx4 v[112:115], v2, s[36:39], s64 offen nt
    buffer_load_dwordx4 v[116:119], v2, s[36:39], s64 offen offset:1024 nt
    s_waitcnt vmcnt(10)
    v_and_b32_dpp v44, v49, v14 row_newbcast:14 row_mask:0xf bank_mask:0xf
    v_and_b32_dpp v45, v49, v15 row_newbcast:14 row_mask:0xf bank_mask:0xf
    v_and_b32_dpp v46, v49, v16 row_newbcast:14 row_mask:0xf bank_mask:0xf
    v_and_b32_dpp v47, v49, v17 row_newbcast:14 row_mask:0xf bank_mask:0xf
    s_nop 1
    v_smfmac_f32_16x16x64_bf16 v[36:39], v[44:47], v[72:79], v22
    s_mov_b32 s64, 253952
    buffer_load_dwordx4 v[120:123], v2, s[36:39], s64 offen nt
    buffer_load_dwordx4 v[124:127], v2, s[36:39], s64 offen offset:1024 nt
    s_waitcnt vmcnt(10)
    v_and_b32_dpp v40, v49, v14 row_newbcast:3 row_mask:0xf bank_mask:0xf
    v_and_b32_dpp v41, v49, v15 row_newbcast:3 row_mask:0xf bank_mask:0xf
    v_and_b32_dpp v42, v49, v16 row_newbcast:3 row_mask:0xf bank_mask:0xf
    v_and_b32_dpp v43, v49, v17 row_newbcast:3 row_mask:0xf bank_mask:0xf
    s_nop 1
    v_smfmac_f32_16x16x64_bf16 v[36:39], v[40:43], v[80:87], v22
    s_lshl_b32 s66, 1, s31
    s_not_b32 s66, s66
    v_mov_b32 v19, s66
    s_and_b32 s15, s15, 0x1000000
    s_and_b32 s101, s101, 0x1000000
    s_branch L_pg4
.p2align 12
L_pad4:
    s_branch L_touched
    s_nop 0
L_pg4:
    s_mov_b32 s71, 0xff
    s_mov_b32 s72, 0
    v_lshrrev_b32 v60, 2, v12
    v_lshlrev_b32 v60, 7, v60
    v_lshrrev_b32 v52, 1, v11
    v_lshl_add_u32 v60, v52, 6, v60
    v_and_b32 v52, 1, v0
    v_lshl_add_u32 v60, v52, 5, v60
    v_and_b32 v52, 1, v11
    v_lshl_add_u32 v60, v52, 4, v60
    v_bfe_u32 v52, v0, 1, 1
    v_lshl_add_u32 v60, v52, 3, v60
    v_mov_b32 v224, 0
    v_mov_b32 v225, 0
    v_mov_b32 v226, 0
    v_mov_b32 v227, 0
    v_mov_b32 v228, 0
    v_mov_b32 v229, 0
    v_mov_b32 v230, 0
    v_mov_b32 v231, 0
    v_mov_b32 v232, 0
    v_mov_b32 v233, 0
    v_mov_b32 v234, 0
    v_mov_b32 v235, 0
    v_mov_b32 v236, 0
    v_mov_b32 v237, 0
    v_mov_b32 v238, 0
    v_mov_b32 v239, 0
    v_mov_b32 v240, 0
    v_mov_b32 v241, 0
    v_mov_b32 v242, 0
    v_mov_b32 v243, 0
    v_mov_b32 v244, 0
    v_mov_b32 v245, 0
    v_mov_b32 v246, 0
    v_mov_b32 v247, 0
    v_mov_b32 v248, 0
    v_mov_b32 v249, 0
    v_mov_b32 v250, 0
    v_mov_b32 v251, 0
    v_mov_b32 v252, 0
    v_mov_b32 v253, 0
    v_mov_b32 v254, 0
    v_mov_b32 v255, 0
    v_mov_b32 v61, 0
    v_lshlrev_b32 v2, 9, v11
    v_lshl_add_u32 v2, v12, 4, v2
    v_mov_b32 v212, 0
    v_mov_b32 v213, 0
    v_mov_b32 v214, 0
    v_mov_b32 v215, 0
    v_mov_b32 v20, 0x3727c5ac
    v_mov_b32 v21, 0xc0135761
    v_mov_b32 v52, 0x1000000
    v_mov_b32 v53, 9472
    v_cmp_gt_u32 vcc, 32, v10
    s_nop 1
    v_cndmask_b32 v27, v53, v27, vcc
    v_cndmask_b32 v1, v52, v1, vcc
    v_and_b32 v5, 3, v0
    v_lshlrev_b32 v5, 3, v5
    v_cmp_gt_u32 vcc, 16, v10
    s_nop 1
    v_cndmask_b32 v7, v52, v7, vcc
    v_cmp_gt_u32 vcc, 16, v10
    s_nop 1
    v_cndmask_b32 v23, v52, v23, vcc
    v_lshlrev_b32 v62, 3, v13
    s_mov_b32 s76, 0
    s_mov_b32 s77, 0x80000000
    s_mov_b32 s78, 0x000000ff
    s_mov_b32 s79, 0x0000ff00
    v_mov_b32 v63, 0x3f803f80
    v_lshlrev_b32 v24, 16, v24
    s_waitcnt vmcnt(8)
    v_accvgpr_write_b32 a100, v88
    v_accvgpr_write_b32 a108, v89
    v_accvgpr_write_b32 a116, v90
    v_accvgpr_write_b32 a124, v91
    v_accvgpr_write_b32 a101, v92
    v_accvgpr_write_b32 a109, v93
    v_accvgpr_write_b32 a117, v94
    v_accvgpr_write_b32 a125, v95
    s_add_u32 s64, s74, 0
    s_nop 0
    buffer_load_dwordx4 a[192:195], v6, s[52:55], s64 offen
    s_add_u32 s64, s74, 2048
    buffer_load_dwordx4 a[196:199], v6, s[52:55], s64 offen
    v_and_b32_dpp v44, v49, v14 row_newbcast:11 row_mask:0xf bank_mask:0xf
    v_and_b32_dpp v45, v49, v15 row_newbcast:11 row_mask:0xf bank_mask:0xf
    v_and_b32_dpp v46, v49, v16 row_newbcast:11 row_mask:0xf bank_mask:0xf
    v_and_b32_dpp v47, v49, v17 row_newbcast:11 row_mask:0xf bank_mask:0xf
    s_waitcnt vmcnt(8)
    s_nop 0
    v_smfmac_f32_16x16x64_bf16 v[36:39], v[44:47], v[96:103], v22
    s_add_u32 s64, s74, 4096
    buffer_load_dwordx4 a[200:203], v6, s[52:55], s64 offen
    s_add_u32 s64, s74, 6144
    buffer_load_dwordx4 a[204:207], v6, s[52:55], s64 offen
    s_waitcnt vmcnt(8)
    s_nop 0
    v_accvgpr_write_b32 a102, v104
    v_accvgpr_write_b32 a110, v105
    v_accvgpr_write_b32 a118, v106
    v_accvgpr_write_b32 a126, v107
    v_accvgpr_write_b32 a103, v108
    v_accvgpr_write_b32 a111, v109
    v_accvgpr_write_b32 a119, v110
    v_accvgpr_write_b32 a127, v111
    s_add_u32 s64, s74, 8192
    buffer_load_dwordx4 a[208:211], v6, s[52:55], s64 offen
    s_add_u32 s64, s74, 10240
    buffer_load_dwordx4 a[212:215], v6, s[52:55], s64 offen
    v_and_b32_dpp v40, v49, v14 row_newbcast:7 row_mask:0xf bank_mask:0xf
    v_and_b32_dpp v41, v49, v15 row_newbcast:7 row_mask:0xf bank_mask:0xf
    v_and_b32_dpp v42, v49, v16 row_newbcast:7 row_mask:0xf bank_mask:0xf
    v_and_b32_dpp v43, v49, v17 row_newbcast:7 row_mask:0xf bank_mask:0xf
    s_waitcnt vmcnt(8)
    s_nop 0
    v_smfmac_f32_16x16x64_bf16 v[36:39], v[40:43], v[112:119], v22
    s_add_u32 s64, s74, 12288
    buffer_load_dwordx4 a[216:219], v6, s[52:55], s64 offen
    s_add_u32 s64, s74, 14336
    buffer_load_dwordx4 a[220:223], v6, s[52:55], s64 offen
    v_and_b32_dpp v44, v49, v14 row_newbcast:15 row_mask:0xf bank_mask:0xf
    v_and_b32_dpp v45, v49, v15 row_newbcast:15 row_mask:0xf bank_mask:0xf
    v_and_b32_dpp v46, v49, v16 row_newbcast:15 row_mask:0xf bank_mask:0xf
    v_and_b32_dpp v47, v49, v17 row_newbcast:15 row_mask:0xf bank_mask:0xf
    s_waitcnt vmcnt(8)
    s_nop 0
    v_smfmac_f32_16x16x64_bf16 v[36:39], v[44:47], v[120:127], v22
    s_nop 7
    ds_write_b128 v27, v[36:39] offset:2048
    s_waitcnt lgkmcnt(0)
    s_barrier
    buffer_atomic_and v19, v23, s[56:59], s15 offen offset:1024 sc1
    ds_read_b64 v[52:53], v60 offset:2048
    ds_read_b64 v[54:55], v60 offset:2560
    ds_read_b64 v[56:57], v60 offset:3072
    ds_read_b64 v[58:59], v60 offset:3584
    s_waitcnt lgkmcnt(0)
    v_pk_add_f32 v[52:53], v[52:53], v[54:55]
    v_pk_add_f32 v[56:57], v[56:57], v[58:59]
    v_pk_add_f32 v[52:53], v[52:53], v[56:57]
    v_cvt_pk_bf16_f32 v60, v52, v53
    s_load_dword s4, s[12:13], 1024 glc
    s_nop 0
    s_nop 0
    v_mov_b32_dpp v40, v60 row_newbcast:0 row_mask:0xf bank_mask:0xf
    v_mov_b32_dpp v41, v60 row_newbcast:1 row_mask:0xf bank_mask:0xf
    v_mov_b32_dpp v42, v60 row_newbcast:2 row_mask:0xf bank_mask:0xf
    v_mov_b32_dpp v43, v60 row_newbcast:3 row_mask:0xf bank_mask:0xf
    v_mov_b32_dpp v44, v60 row_newbcast:4 row_mask:0xf bank_mask:0xf
    v_mov_b32_dpp v45, v60 row_newbcast:5 row_mask:0xf bank_mask:0xf
    v_smfmac_f32_16x16x64_bf16 v[224:227], v[40:43], a[0:7], v18
    v_mov_b32_dpp v46, v60 row_newbcast:6 row_mask:0xf bank_mask:0xf
    v_smfmac_f32_16x16x64_bf16 v[228:231], v[40:43], a[8:15], v18
    v_mov_b32_dpp v47, v60 row_newbcast:7 row_mask:0xf bank_mask:0xf
    v_smfmac_f32_16x16x64_bf16 v[232:235], v[40:43], a[16:23], v18
    v_mov_b32_dpp v56, v60 row_newbcast:8 row_mask:0xf bank_mask:0xf
    v_smfmac_f32_16x16x64_bf16 v[236:239], v[40:43], a[24:31], v18
    v_mov_b32_dpp v57, v60 row_newbcast:9 row_mask:0xf bank_mask:0xf
    v_smfmac_f32_16x16x64_bf16 v[224:227], v[44:47], a[32:39], v18
    v_mov_b32_dpp v58, v60 row_newbcast:10 row_mask:0xf bank_mask:0xf
    v_smfmac_f32_16x16x64_bf16 v[228:231], v[44:47], a[40:47], v18
    v_mov_b32_dpp v59, v60 row_newbcast:11 row_mask:0xf bank_mask:0xf
    v_smfmac_f32_16x16x64_bf16 v[232:235], v[44:47], a[48:55], v18
    v_mov_b32_dpp v40, v60 row_newbcast:12 row_mask:0xf bank_mask:0xf
    v_smfmac_f32_16x16x64_bf16 v[236:239], v[44:47], a[56:63], v18
    v_mov_b32_dpp v41, v60 row_newbcast:13 row_mask:0xf bank_mask:0xf
    v_smfmac_f32_16x16x64_bf16 v[224:227], v[56:59], a[64:71], v18
    v_mov_b32_dpp v42, v60 row_newbcast:14 row_mask:0xf bank_mask:0xf
    v_smfmac_f32_16x16x64_bf16 v[228:231], v[56:59], a[72:79], v18
    v_mov_b32_dpp v43, v60 row_newbcast:15 row_mask:0xf bank_mask:0xf
    v_smfmac_f32_16x16x64_bf16 v[232:235], v[56:59], a[80:87], v18
    v_smfmac_f32_16x16x64_bf16 v[236:239], v[56:59], a[88:95], v18
    v_smfmac_f32_16x16x64_bf16 v[224:227], v[40:43], a[96:103], v18
    v_smfmac_f32_16x16x64_bf16 v[228:231], v[40:43], a[104:111], v18
    v_smfmac_f32_16x16x64_bf16 v[232:235], v[40:43], a[112:119], v18
    v_smfmac_f32_16x16x64_bf16 v[236:239], v[40:43], a[120:127], v18
    s_nop 4
    v_cvt_pk_bf16_f32 v52, v224, v225
    v_min_u32 v52, -2, v52
    v_cvt_pk_bf16_f32 v53, v228, v229
    v_min_u32 v53, -2, v53
    v_cvt_pk_bf16_f32 v54, v232, v233
    v_min_u32 v54, -2, v54
    v_cvt_pk_bf16_f32 v55, v236, v237
    v_min_u32_e64 v55, -2, v55
    buffer_store_dwordx4 v[52:55], v7, s[56:59], s70 offen sc1
    s_add_u32 s64, s74, 16384
    buffer_load_dwordx4 a[224:227], v6, s[52:55], s64 offen
    s_add_u32 s64, s74, 18432
    buffer_load_dwordx4 a[228:231], v6, s[52:55], s64 offen
    s_add_u32 s64, s74, 20480
    buffer_load_dwordx4 a[232:235], v6, s[52:55], s64 offen
    s_add_u32 s64, s74, 22528
    buffer_load_dwordx4 a[236:239], v6, s[52:55], s64 offen
L_hintA:
    s_waitcnt lgkmcnt(0)
    s_lshr_b32 s66, s4, 16
    s_or_b32 s66, s66, s4
    s_lshr_b32 s67, s66, 8
    s_or_b32 s66, s66, s67
    s_andn2_b32 s66, s71, s66
    s_cbranch_scc0 L_ha_none
    s_andn2_b32 s71, s71, s66
    s_and_b32 s67, s66, 15
    s_cbranch_scc0 L_ha_h0
    s_bitcmp1_b32 s66, 0
    s_cbranch_scc0 L_ha0
    s_mov_b32 s64, 0
    buffer_load_dwordx4 v[176:179], v8, s[56:59], s64 offen sc1
L_ha0:
    s_bitcmp1_b32 s66, 1
    s_cbranch_scc0 L_ha1
    s_mov_b32 s64, 2176
    buffer_load_dwordx4 v[180:183], v8, s[56:59], s64 offen sc1
L_ha1:
    s_bitcmp1_b32 s66, 2
    s_cbranch_scc0 L_ha2
    s_mov_b32 s64, 4352
    buffer_load_dwordx4 v[184:187], v8, s[56:59], s64 offen sc1
L_ha2:
    s_bitcmp1_b32 s66, 3
    s_cbranch_scc0 L_ha3
    s_mov_b32 s64, 6528
    buffer_load_dwordx4 v[188:191], v8, s[56:59], s64 offen sc1
L_ha3:
L_ha_h0:
    s_and_b32 s67, s66, 240
    s_cbranch_scc0 L_ha_h1
    s_bitcmp1_b32 s66, 4
    s_cbranch_scc0 L_ha4
    s_mov_b32 s64, 8704
    buffer_load_dwordx4 v[192:195], v8, s[56:59], s64 offen sc1
L_ha4:
    s_bitcmp1_b32 s66, 5
    s_cbranch_scc0 L_ha5
    s_mov_b32 s64, 10880
    buffer_load_dwordx4 v[196:199], v8, s[56:59], s64 offen sc1
L_ha5:
    s_bitcmp1_b32 s66, 6
    s_cbranch_scc0 L_ha6
    s_mov_b32 s64, 13056
    buffer_load_dwordx4 v[200:203], v8, s[56:59], s64 offen sc1
L_ha6:
    s_bitcmp1_b32 s66, 7
    s_cbranch_scc0 L_ha7
    s_mov_b32 s64, 15232
    buffer_load_dwordx4 v[204:207], v8, s[56:59], s64 offen sc1
L_ha7:
L_ha_h1:
    s_cmp_eq_u32 s71, 0
    s_cbranch_scc1 L_preA
L_ha_none:
    s_load_dword s4, s[12:13], 1024 glc
    s_add_u32 s72, s72, 1
    s_cmp_le_u32 s72, 0x2000
    s_cbranch_scc1 L_hintA
    s_waitcnt lgkmcnt(0)
    s_mov_b32 s64, 0
    buffer_load_dwordx4 v[176:179], v8, s[56:59], s64 offen sc1
    s_mov_b32 s64, 2176
    buffer_load_dwordx4 v[180:183], v8, s[56:59], s64 offen sc1
    s_mov_b32 s64, 4352
    buffer_load_dwordx4 v[184:187], v8, s[56:59], s64 offen sc1
    s_mov_b32 s64, 6528
    buffer_load_dwordx4 v[188:191], v8, s[56:59], s64 offen sc1
    s_mov_b32 s64, 8704
    buffer_load_dwordx4 v[192:195], v8, s[56:59], s64 offen sc1
    s_mov_b32 s64, 10880
    buffer_load_dwordx4 v[196:199], v8, s[56:59], s64 offen sc1
    s_mov_b32 s64, 13056
    buffer_load_dwordx4 v[200:203], v8, s[56:59], s64 offen sc1
    s_mov_b32 s64, 15232
    buffer_load_dwordx4 v[204:207], v8, s[56:59], s64 offen sc1
L_preA:
    ds_read_b128 v[216:219], v2 offset:6400
    ds_read_b128 v[220:223], v2 offset:6656
    v_mov_b32 v36, v34
    v_mov_b32 v37, v35
    v_mov_b32 v38, 0
    v_mov_b32_e64 v39, 0
    s_waitcnt lgkmcnt(0)
    v_pk_add_f32 v[216:217], v[216:217], v[220:221]
    v_pk_add_f32 v[218:219], v[218:219], v[222:223]
    s_nop 1
    v_permlane32_swap_b32 v216, v218
    v_permlane32_swap_b32 v217, v219
    v_add_f32 v216, v216, v218
    v_add_f32 v217, v217, v219
    s_nop 1
    v_permlane16_swap_b32 v216, v217
    v_add_f32 v216, v216, v217
    v_mov_b32 v26, v216
    s_waitcnt vmcnt(0)
L_sumA:
    v_smfmac_f32_16x16x64_bf16 v[36:39], v[30:33], v[176:183], v3
    v_smfmac_f32_16x16x64_bf16 v[36:39], v[30:33], v[184:191], v3
    v_smfmac_f32_16x16x64_bf16 v[36:39], v[30:33], v[192:199], v3
    v_smfmac_f32_16x16x64_bf16 v[36:39], v[30:33], v[200:207], v3
    s_nop 7
    v_cmp_u_f32 vcc, v36, v37
    v_cvt_pk_bf16_f32 v60, v36, v37
    s_cbranch_vccnz L_chkA
L_pollA_done:
    s_nop 0
    ds_write_b32 v28, v60 offset:8448
    v_dot2_f32_bf16 v54, v60, v63, 0
    v_dot2_f32_bf16 v55, v60, v60, 0
    v_mov_b32_dpp v40, v60 row_newbcast:0 row_mask:0xf bank_mask:0x3
    v_mov_b32_dpp v41, v60 row_newbcast:1 row_mask:0xf bank_mask:0x3
    v_mov_b32_dpp v42, v60 row_newbcast:2 row_mask:0xf bank_mask:0x3
    v_mov_b32_dpp v43, v60 row_newbcast:3 row_mask:0xf bank_mask:0x3
    v_mov_b32_dpp v40, v60 row_newbcast:8 row_mask:0xf bank_mask:0xc
    v_mov_b32_dpp v41, v60 row_newbcast:9 row_mask:0xf bank_mask:0xc
    v_mov_b32_dpp v42, v60 row_newbcast:10 row_mask:0xf bank_mask:0xc
    v_mov_b32_dpp v43, v60 row_newbcast:11 row_mask:0xf bank_mask:0xc
    v_add_f32_dpp v54, v54, v54 row_ror:8 row_mask:0xf bank_mask:0xf
    v_add_f32_dpp v55, v55, v55 row_ror:8 row_mask:0xf bank_mask:0xf
    v_smfmac_f32_16x16x64_bf16 v[240:243], v[40:43], a[128:135], v18
    v_mov_b32_dpp v44, v60 row_newbcast:4 row_mask:0xf bank_mask:0x3
    v_mov_b32_dpp v45, v60 row_newbcast:5 row_mask:0xf bank_mask:0x3
    v_smfmac_f32_16x16x64_bf16 v[244:247], v[40:43], a[136:143], v18
    v_mov_b32_dpp v46, v60 row_newbcast:6 row_mask:0xf bank_mask:0x3
    v_mov_b32_dpp v47, v60 row_newbcast:7 row_mask:0xf bank_mask:0x3
    v_smfmac_f32_16x16x64_bf16 v[248:251], v[40:43], a[144:151], v18
    v_mov_b32_dpp v44, v60 row_newbcast:12 row_mask:0xf bank_mask:0xc
    v_mov_b32_dpp v45, v60 row_newbcast:13 row_mask:0xf bank_mask:0xc
    v_smfmac_f32_16x16x64_bf16 v[252:255], v[40:43], a[152:159], v18
    v_mov_b32_dpp v46, v60 row_newbcast:14 row_mask:0xf bank_mask:0xc
    v_mov_b32_dpp v47, v60 row_newbcast:15 row_mask:0xf bank_mask:0xc
    v_add_f32_dpp v54, v54, v54 row_ror:4 row_mask:0xf bank_mask:0xf
    v_add_f32_dpp v55, v55, v55 row_ror:4 row_mask:0xf bank_mask:0xf
    v_smfmac_f32_16x16x64_bf16 v[240:243], v[44:47], a[160:167], v18
    v_add_f32_dpp v54, v54, v54 row_ror:2 row_mask:0xf bank_mask:0xf
    v_add_f32_dpp v55, v55, v55 row_ror:2 row_mask:0xf bank_mask:0xf
    v_smfmac_f32_16x16x64_bf16 v[244:247], v[44:47], a[168:175], v18
    v_add_f32_dpp v54, v54, v54 row_ror:1 row_mask:0xf bank_mask:0xf
    v_add_f32_dpp v55, v55, v55 row_ror:1 row_mask:0xf bank_mask:0xf
    v_smfmac_f32_16x16x64_bf16 v[248:251], v[44:47], a[176:183], v18
    v_add_f32_dpp v54, v54, v54 row_bcast:15 row_mask:0xa bank_mask:0xf
    v_add_f32_dpp v55, v55, v55 row_bcast:15 row_mask:0xa bank_mask:0xf
    v_smfmac_f32_16x16x64_bf16 v[252:255], v[44:47], a[184:191], v18
    v_add_f32_dpp v54, v54, v54 row_bcast:31 row_mask:0xc bank_mask:0xf
    v_add_f32_dpp v55, v55, v55 row_bcast:31 row_mask:0xc bank_mask:0xf
    s_mov_b64 exec, s[76:77]
    ds_write_b64 v62, v[54:55] offset:4160
    s_mov_b64 exec, s[78:79]
    ds_write2_b64 v51, v[240:241], v[244:245] offset0:0 offset1:1
    s_nop 1
    ds_write2_b64 v51, v[248:249], v[252:253] offset0:2 offset1:3
    s_mov_b64 exec, -1
    s_waitcnt lgkmcnt(0)
    s_barrier
    ds_read_b64 v[52:53], v5 offset:4160
    ds_read_b128 v[216:219], v2 offset:4352
    ds_read_b128 v[220:223], v2 offset:4608
    v_mov_b32 v36, 0
    v_mov_b32 v37, 0
    v_mov_b32 v38, 0
    v_mov_b32_e64 v39, 0
    s_waitcnt lgkmcnt(2)
    v_add_f32_dpp v52, v52, v52 quad_perm:[1,0,3,2] row_mask:0xf bank_mask:0xf
    v_add_f32_dpp v53, v53, v53 quad_perm:[1,0,3,2] row_mask:0xf bank_mask:0xf
    s_nop 0
    v_add_f32_dpp v52, v52, v52 quad_perm:[2,3,0,1] row_mask:0xf bank_mask:0xf
    v_add_f32_dpp v53, v53, v53 quad_perm:[2,3,0,1] row_mask:0xf bank_mask:0xf
    v_mul_f32 v52, 0x3b000000, v52
    v_fmamk_f32 v53, v53, 0x3b000000, v20
    s_waitcnt lgkmcnt(0)
    v_pk_add_f32 v[216:217], v[216:217], v[220:221]
    v_pk_add_f32 v[218:219], v[218:219], v[222:223]
    v_fma_f32 v53, -v52, v52, v53
    v_max_f32 v53, v53, v20
    v_permlane32_swap_b32 v216, v218
    v_permlane32_swap_b32 v217, v219
    v_add_f32 v216, v216, v218
    v_add_f32 v217, v217, v219
    v_rsq_f32 v53, v53
    s_lshl_b32 s66, s31, 5
    v_permlane16_swap_b32 v216, v217
    v_add_f32_e64 v216, v216, v217
    v_fma_f32 v55, -v52, v26, v216
    v_fma_f32 v55, v55, v53, v24
    v_mul_f32 v53, v55, v55
    v_fmamk_f32 v54, v53, 0xbdd2d3e8, v21
    v_mul_f32 v54, v54, v55
    v_exp_f32 v54, v54
    s_nop 0
    v_add_f32 v54, 1.0, v54
    v_rcp_f32 v54, v54
    s_nop 0
    v_mul_f32 v55, v55, v54
    v_cvt_pk_bf16_f32 v60, v55, v55
    s_nop 0
    s_nop 0
    v_and_b32_dpp v40, v60, v14 row_newbcast:0 row_mask:0xf bank_mask:0xf
    v_and_b32_dpp v41, v60, v15 row_newbcast:0 row_mask:0xf bank_mask:0xf
    v_and_b32_dpp v42, v60, v16 row_newbcast:6 row_mask:0xf bank_mask:0xf
    v_and_b32_dpp v43, v60, v17 row_newbcast:6 row_mask:0xf bank_mask:0xf
    v_and_b32_dpp v44, v60, v14 row_newbcast:1 row_mask:0xf bank_mask:0xf
    v_and_b32_dpp v45, v60, v15 row_newbcast:1 row_mask:0xf bank_mask:0xf
    v_and_b32_dpp v46, v60, v16 row_newbcast:7 row_mask:0xf bank_mask:0xf
    v_and_b32_dpp v47, v60, v17 row_newbcast:7 row_mask:0xf bank_mask:0xf
    v_smfmac_f32_16x16x64_bf16 v[36:39], v[40:43], a[192:199], v22
    v_and_b32_dpp v40, v60, v14 row_newbcast:2 row_mask:0xf bank_mask:0xf
    v_and_b32_dpp v41, v60, v15 row_newbcast:2 row_mask:0xf bank_mask:0xf
    v_and_b32_dpp v42, v60, v16 row_newbcast:8 row_mask:0xf bank_mask:0xf
    v_and_b32_dpp v43, v60, v17 row_newbcast:8 row_mask:0xf bank_mask:0xf
    v_smfmac_f32_16x16x64_bf16 v[36:39], v[44:47], a[200:207], v22
    v_and_b32_dpp v44, v60, v14 row_newbcast:3 row_mask:0xf bank_mask:0xf
    v_and_b32_dpp v45, v60, v15 row_newbcast:3 row_mask:0xf bank_mask:0xf
    v_and_b32_dpp v46, v60, v16 row_newbcast:9 row_mask:0xf bank_mask:0xf
    v_and_b32_dpp v47, v60, v17 row_newbcast:9 row_mask:0xf bank_mask:0xf
    v_smfmac_f32_16x16x64_bf16 v[36:39], v[40:43], a[208:215], v22
    v_and_b32_dpp v40, v60, v14 row_newbcast:4 row_mask:0xf bank_mask:0xf
    v_and_b32_dpp v41, v60, v15 row_newbcast:4 row_mask:0xf bank_mask:0xf
    v_and_b32_dpp v42, v60, v16 row_newbcast:10 row_mask:0xf bank_mask:0xf
    v_and_b32_dpp v43, v60, v17 row_newbcast:10 row_mask:0xf bank_mask:0xf
    v_smfmac_f32_16x16x64_bf16 v[36:39], v[44:47], a[216:223], v22
    v_and_b32_dpp v44, v60, v14 row_newbcast:5 row_mask:0xf bank_mask:0xf
    v_and_b32_dpp v45, v60, v15 row_newbcast:5 row_mask:0xf bank_mask:0xf
    v_and_b32_dpp v46, v60, v16 row_newbcast:11 row_mask:0xf bank_mask:0xf
    v_and_b32_dpp v47, v60, v17 row_newbcast:11 row_mask:0xf bank_mask:0xf
    v_smfmac_f32_16x16x64_bf16 v[36:39], v[40:43], a[224:231], v22
    s_nop 0
    v_smfmac_f32_16x16x64_bf16 v[36:39], v[44:47], a[232:239], v22
    s_nop 7
    v_cvt_pk_bf16_f32 v52, v36, v37
    v_cvt_pk_bf16_f32 v53, v38, v39
    v_min_u32 v52, -2, v52
    v_min_u32 v53, -2, v53
    buffer_store_dwordx2 v[52:53], v1, s[56:59], s66 offen offset:1152 sc1
    s_cmp_lg_u32 s3, 0
    s_cbranch_scc1 L_end
    ds_read_b32 v58, v50 offset:8448
    s_lshl_b32 s68, s30, 10
    v_add_u32 v50, s68, v50
    s_mov_b32 s72, 0
    v_lshlrev_b32 v54, 16, v25
    v_and_b32 v55, 0xffff0000, v25
    s_waitcnt lgkmcnt(0)
    v_lshlrev_b32 v56, 16, v58
    v_and_b32 v57, 0xffff0000, v58
    v_pk_add_f32 v[54:55], v[54:55], v[56:57]
    v_cmp_gt_u32 vcc, 2, v12
    s_nop 1
    v_cndmask_b32 v54, 0, v54, vcc
    v_cndmask_b32 v55, 0, v55, vcc
    s_waitcnt vmcnt(0)
L_pollB:
    buffer_load_dwordx4 v[208:211], v9, s[56:59], s70 offen offset:1152 sc1
    v_mov_b32 v36, v54
    v_mov_b32 v37, v55
    v_mov_b32 v38, 0
    v_mov_b32_e64 v39, 0
    s_waitcnt vmcnt(0)
    s_nop 0
    v_smfmac_f32_16x16x64_bf16 v[36:39], v[30:33], v[208:215], v3
    v_max3_u32 v56, v208, v209, v210
    v_max_u32 v56, v56, v211
    v_cmp_eq_u32 vcc, -1, v56
    s_nop 0
    s_cbranch_vccnz L_retryB
L_pollB_done:
    s_nop 0
    s_nop 1
    v_add_f32_dpp v36, v36, v36 row_ror:8 row_mask:0xf bank_mask:0xf
    v_add_f32_dpp v37, v37, v37 row_ror:8 row_mask:0xf bank_mask:0xf
    s_nop 0
    v_add_f32_dpp v36, v36, v36 row_ror:4 row_mask:0xf bank_mask:0xf
    v_add_f32_dpp v37, v37, v37 row_ror:4 row_mask:0xf bank_mask:0xf
    s_nop 0
    v_add_f32_dpp v36, v36, v36 row_ror:2 row_mask:0xf bank_mask:0xf
    v_add_f32_dpp v37, v37, v37 row_ror:2 row_mask:0xf bank_mask:0xf
    v_cvt_pk_bf16_f32 v52, v36, v37
    global_store_dword v50, v52, s[24:25]
L_end:
    s_endpgm
L_chkA:
    s_nop 0
    v_max3_u32 v56, v176, v177, v178
    v_max3_u32 v56, v56, v179, v180
    v_max3_u32 v56, v56, v181, v182
    v_max3_u32 v56, v56, v183, v184
    v_max3_u32 v56, v56, v185, v186
    v_max3_u32 v56, v56, v187, v188
    v_max3_u32 v56, v56, v189, v190
    v_max3_u32 v56, v56, v191, v192
    v_max3_u32 v56, v56, v193, v194
    v_max3_u32 v56, v56, v195, v196
    v_max3_u32 v56, v56, v197, v198
    v_max3_u32 v56, v56, v199, v200
    v_max3_u32 v56, v56, v201, v202
    v_max3_u32 v56, v56, v203, v204
    v_max3_u32 v56, v56, v205, v206
    v_max_u32 v56, v56, v207
    v_cmp_eq_u32 vcc, -1, v56
    s_nop 0
    s_cbranch_vccz L_pollA_done
    s_add_u32 s72, s72, 1
    s_cmp_gt_u32 s72, 0x40000
    s_cbranch_scc1 L_pollA_done
    s_mov_b32 s64, 0
    s_nop 0
    buffer_load_dwordx4 v[176:179], v8, s[56:59], s64 offen sc1
    s_mov_b32 s64, 2176
    buffer_load_dwordx4 v[180:183], v8, s[56:59], s64 offen sc1
    s_mov_b32 s64, 4352
    buffer_load_dwordx4 v[184:187], v8, s[56:59], s64 offen sc1
    s_mov_b32 s64, 6528
    buffer_load_dwordx4 v[188:191], v8, s[56:59], s64 offen sc1
    s_mov_b32 s64, 8704
    buffer_load_dwordx4 v[192:195], v8, s[56:59], s64 offen sc1
    s_mov_b32 s64, 10880
    buffer_load_dwordx4 v[196:199], v8, s[56:59], s64 offen sc1
    s_mov_b32 s64, 13056
    buffer_load_dwordx4 v[200:203], v8, s[56:59], s64 offen sc1
    s_mov_b32 s64, 15232
    buffer_load_dwordx4 v[204:207], v8, s[56:59], s64 offen sc1
    v_mov_b32 v36, v34
    v_mov_b32 v37, v35
    v_mov_b32 v38, 0
    v_mov_b32 v39, 0
    s_waitcnt vmcnt(0)
    s_nop 1
    s_branch L_sumA
L_retryB:
    s_add_u32 s72, s72, 1
    s_cmp_gt_u32 s72, 0x40000
    s_nop 4
    s_cbranch_scc1 L_pollB_done
    s_branch L_pollB
L_codeend:
.section .rodata,"a"
.p2align 6
.amdhsa_kernel sequential_preLN__sliding_block_cached__dense_activation_gelu__decode_kernel
.amdhsa_next_free_vgpr 496
.amdhsa_next_free_sgpr 102
.amdhsa_accum_offset 256
.amdhsa_group_segment_fixed_size 0
.amdhsa_kernarg_size 104
.amdhsa_user_sgpr_count 2
.amdhsa_user_sgpr_kernarg_segment_ptr 1
.amdhsa_system_sgpr_workgroup_id_x 1
.amdhsa_float_denorm_mode_32 3
.end_amdhsa_kernel
```
